```python
import torch

def _softmax(x, axis=-1):
    return torch.softmax(x, dim=axis)

def _gelu(x):
    return torch.nn.functional.gelu(x, approximate='tanh')

def _silu(x):
    return torch.nn.functional.silu(x)

def _sigmoid(x):
    return torch.sigmoid(x)

def _layernorm(x, axis=-1, eps=1e-05):
    m = x.mean(dim=axis, keepdim=True)
    v = x.var(dim=axis, keepdim=True, unbiased=False)
    return (x - m) / torch.sqrt(v + eps)

def _scatter_add(tgt, idx, src, axis=0):
    return tgt.clone().index_add_(axis, idx, src)

def _segment_sum(src, seg, n):
    out = torch.zeros((n,) + src.shape[1:], dtype=src.dtype)
    return out.index_add_(0, seg, src)

def _pad(x, pw):
    flat = tuple((v for pair in reversed(pw) for v in pair))
    return torch.nn.functional.pad(x, flat)
kernel_name = 'adaLN_cond__ssm_conv_s4d__glu_gated_swiglu__prompt'

def setup_inputs():

    _w = lambda a: (lambda t: t.to(torch.bfloat16) if t.is_floating_point() else t)(torch.as_tensor(a))

    def _A_setup():
        Bsz, L, D, N = (1, 2048, 640, 128)
        return {'u': _w((lambda *s: torch.randn(*s, dtype=torch.bfloat16) * 0.05)(Bsz, L, D)), 'log_A_real': _w((lambda *s: torch.randn(*s, dtype=torch.bfloat16) * 3.2)(D, N) * 0.5), 'A_imag': _w((lambda *s: torch.randn(*s, dtype=torch.bfloat16) * 0.05)(D, N) * 3.14), 'C_real': _w((lambda *s: torch.randn(*s, dtype=torch.bfloat16) * 0.2)(D, N) / N ** 0.5), 'C_imag': _w((lambda *s: torch.randn(*s, dtype=torch.bfloat16) * 0.2)(D, N) / N ** 0.5), 'log_dt': _w((lambda *s: torch.randn(*s, dtype=torch.bfloat16) * 0.05)(D) * 0.5 - 4.0), 'D_skip': _w((lambda *s: torch.randn(*s, dtype=torch.bfloat16) * 0.05)(D))}
    _A_in = _A_setup()

    def _B_setup():
        B, S, D, F = (1, 2048, 640, 1728)
        return {'x': _w((lambda *s: torch.randn(*s, dtype=torch.bfloat16) * 0.05)(B, S, D)), 'w1': _w((lambda *s: torch.randn(*s, dtype=torch.bfloat16) * 0.4)(D, F) * (2.0 / D) ** 0.5), 'w3': _w((lambda *s: torch.randn(*s, dtype=torch.bfloat16) * 0.4)(D, F) * (2.0 / D) ** 0.5), 'w2': _w((lambda *s: torch.randn(*s, dtype=torch.bfloat16) * 0.4)(F, D) * (2.0 / F) ** 0.5)}
    _B_in = _B_setup()
    return {'A_u': _A_in['u'], 'A_log_A_real': _A_in['log_A_real'], 'A_A_imag': _A_in['A_imag'], 'A_C_real': _A_in['C_real'], 'A_C_imag': _A_in['C_imag'], 'A_log_dt': _A_in['log_dt'], 'A_D_skip': _A_in['D_skip'], 'B_x': _B_in['x'], 'B_w1': _B_in['w1'], 'B_w3': _B_in['w3'], 'B_w2': _B_in['w2'], 'c': _w((lambda *s: torch.randn(*s, dtype=torch.bfloat16) * 0.2)(1, 640) * 8.0), 'w_mod': _w((lambda *s: torch.randn(*s, dtype=torch.bfloat16) * 0.2)(640, 6 * 640) * 640 ** (-0.5) * 8.0)}

def reference(A_u, A_log_A_real, A_A_imag, A_C_real, A_C_imag, A_log_dt, A_D_skip, B_x, B_w1, B_w3, B_w2, c, w_mod):

    def _A_ref(u, log_A_real, A_imag, C_real, C_imag, log_dt, D_skip):
        L = u.shape[1]
        dt = torch.exp(log_dt)
        A = -torch.exp(log_A_real) + 1j * A_imag
        C = (C_real + 1j * C_imag) * dt[:, None]
        pos = (lambda x, dt: x.to(dt))(torch.arange(L), log_dt.dtype)
        P = torch.exp((A * dt[:, None])[:, :, None] * pos[None, None, :])
        K = 2.0 * torch.einsum('dn,dnl->dl', C, P).real
        L2 = 2 * L
        u_t = (lambda x, *d: x.permute(*d))(u, 0, 2, 1)
        Kf = (lambda x, *a, **k: torch.fft.rfft(x.float(), *a, **k))(K, L2)
        Uf = (lambda x, *a, **k: torch.fft.rfft(x.float(), *a, **k))(u_t, L2)
        y = (lambda x, *a, **k: torch.fft.irfft(x, *a, **k).to(torch.bfloat16))(Uf * Kf[None, :, :], L2)[:, :, :L]
        y = (lambda x, *d: x.permute(*d))(y, 0, 2, 1)
        return y + u * D_skip[None, None, :]

    def _B_ref(x, w1, w3, w2):
        gate = torch.einsum('bsd,df->bsf', x, w1)
        up = torch.einsum('bsd,df->bsf', x, w3)
        h = _silu(gate) * up
        out = torch.einsum('bsf,fd->bsd', h, w2)
        return out
    x = A_u
    mod = (_silu(c) @ w_mod).reshape(c.shape[0], 6, 1, -1)
    sa, ca, ga, sb, cb, gb = (mod[:, 0].clone(), mod[:, 1].clone(), mod[:, 2].clone(), mod[:, 3].clone(), mod[:, 4].clone(), mod[:, 5].clone())
    h = _layernorm(x, axis=-1) * (1 + ca) + sa
    x = x + ga * _A_ref(h, A_log_A_real, A_A_imag, A_C_real, A_C_imag, A_log_dt, A_D_skip)
    h = _layernorm(x, axis=-1) * (1 + cb) + sb
    x = x + gb * _B_ref(h, B_w1, B_w3, B_w2)
    return x
```

```asm
; @launch kernel=ka_kernel grid=(424,1,1) block=(256,1,1) lds=57856
; @launch kernel=kb_kernel grid=(254,1,1) block=(256,1,1) lds=68096
; @launch kernel=kc_kernel grid=(248,1,1) block=(768,1,1) lds=147456
; @launch kernel=kd_kernel grid=(256,1,1) block=(512,1,1) lds=93184
.amdgcn_target "amdgcn-amd-amdhsa--gfx950"
.text
.globl ka_kernel
.p2align 8
.type ka_kernel,@function
ka_kernel:
    s_cmp_ge_u32 s2, 424
    s_cbranch_scc1 A_end
    s_sub_u32 s4, s2, 224
    s_cmp_ge_u32 s2, 256
    s_cbranch_scc1 A_m
    s_cmp_ge_u32 s2, 192
    s_cbranch_scc1 A_x
    s_sub_u32 s4, s2, 160
    s_cmp_ge_u32 s2, 160
    s_cbranch_scc1 A_m
    s_load_dwordx8 s[8:15], s[0:1], 8
    s_load_dwordx2 s[16:17], s[0:1], 40
    s_load_dwordx2 s[18:19], s[0:1], 120
    v_lshrrev_b32 v1, 6, v0
    v_and_b32 v0, 63, v0
    s_nop 0
    v_readfirstlane_b32 s3, v1
    s_lshl_b32 s4, s2, 2
    s_add_u32 s4, s4, s3
    s_lshl_b32 s5, s4, 8
    v_lshlrev_b32 v1, 2, v0
    s_lshl_b32 s6, s4, 1
    v_mov_b32 v2, s6
    s_waitcnt lgkmcnt(0)
    s_mov_b32 s20, s8
    s_mov_b32 s21, s9
    s_mov_b32 s22, 0x28000
    s_mov_b32 s23, 0x00020000
    s_mov_b32 s24, s10
    s_mov_b32 s25, s11
    s_mov_b32 s26, 0x28000
    s_mov_b32 s27, 0x00020000
    s_mov_b32 s28, s12
    s_mov_b32 s29, s13
    s_mov_b32 s30, 0x28000
    s_mov_b32 s31, 0x00020000
    s_mov_b32 s32, s14
    s_mov_b32 s33, s15
    s_mov_b32 s34, 0x28000
    s_mov_b32 s35, 0x00020000
    s_mov_b32 s36, s16
    s_mov_b32 s37, s17
    s_mov_b32 s38, 0x500
    s_mov_b32 s39, 0x00020000
    buffer_load_ushort v8, v2, s[36:39], 0 offen
    buffer_load_dword v4, v1, s[20:23], s5 offen
    buffer_load_dword v5, v1, s[24:27], s5 offen
    buffer_load_dword v6, v1, s[28:31], s5 offen
    buffer_load_dword v7, v1, s[32:35], s5 offen
    s_lshl_b32 s7, s4, 12
    s_add_u32 s7, s7, 0x500000
    s_add_u32 s40, s18, s7
    s_addc_u32 s41, s19, 0
    s_mov_b32 s42, 0x1000
    s_mov_b32 s43, 0x00020000
    s_mul_i32 s7, s3, 14464
    v_add_u32 v9, s7, v1
    v_and_b32 v10, 31, v0
    v_lshrrev_b32 v11, 5, v0
    v_min_u32 v12, 20, v10
    v_add_u32 v12, 32, v12
    v_mul_u32_u24 v12, 272, v12
    v_mul_u32_u24 v13, 272, v10
    v_lshl_add_u32 v14, v11, 4, s7
    v_add_u32 v12, v12, v14
    v_add_u32 v13, v13, v14
    s_mov_b32 s44, 0x3fb8aa3b
    s_mov_b32 s45, 0xffff0000
    s_waitcnt vmcnt(0)
    v_lshlrev_b32 v8, 16, v8
    v_mul_f32 v8, s44, v8
    v_exp_f32 v8, v8
    s_nop 0
    v_cvt_pk_bf16_f32 v8, v8, v8
    v_lshlrev_b32 v8, 16, v8
    v_mov_b32 v64, 0
    v_mov_b32 v65, 0
    v_mov_b32 v66, 0
    v_mov_b32 v67, 0
    v_mov_b32 v68, 0
    v_mov_b32 v69, 0
    v_mov_b32 v70, 0
    v_mov_b32 v71, 0
    v_mov_b32 v72, 0
    v_mov_b32 v73, 0
    v_mov_b32 v74, 0
    v_mov_b32 v75, 0
    v_mov_b32 v76, 0
    v_mov_b32 v77, 0
    v_mov_b32 v78, 0
    v_mov_b32 v79, 0
    s_mov_b32 s47, 2
A_loop:
    v_lshlrev_b32 v16, 16, v4
    v_lshrrev_b32 v4, 16, v4
    v_lshlrev_b32 v17, 16, v5
    v_lshrrev_b32 v5, 16, v5
    v_lshlrev_b32 v18, 16, v6
    v_lshrrev_b32 v6, 16, v6
    v_lshlrev_b32 v19, 16, v7
    v_lshrrev_b32 v7, 16, v7
    v_mul_f32 v16, s44, v16
    v_exp_f32 v16, v16
    s_nop 0
    v_cvt_pk_bf16_f32 v16, v16, v16
    v_lshlrev_b32 v16, 16, v16
    v_mul_f32 v16, v16, v8
    v_mul_f32 v17, v17, v8
    v_mul_f32 v18, v18, v8
    v_mul_f32 v19, v19, v8
    v_mul_f32 v16, s44, v16
    v_mul_f32 v17, 0.15915494, v17
    v_add_f32 v18, v18, v18
    v_add_f32 v19, v19, v19
    v_mul_f32 v28, -1.0, v16
    v_mul_f32 v29, 1.0, v17
    v_exp_f32 v28, v28
    v_fract_f32 v29, v29
    v_cos_f32 v20, v29
    v_sin_f32 v21, v29
    s_nop 0
    v_mul_f32 v20, v20, v28
    v_mul_f32 v21, v21, v28
    v_mul_f32 v28, -8.0, v16
    v_mul_f32 v29, 8.0, v17
    v_exp_f32 v28, v28
    v_fract_f32 v29, v29
    v_cos_f32 v22, v29
    v_sin_f32 v23, v29
    s_nop 0
    v_mul_f32 v22, v22, v28
    v_mul_f32 v23, v23, v28
    v_mul_f32 v28, -16.0, v16
    v_mul_f32 v29, 16.0, v17
    v_exp_f32 v28, v28
    v_fract_f32 v29, v29
    v_cos_f32 v24, v29
    v_sin_f32 v25, v29
    s_nop 0
    v_mul_f32 v24, v24, v28
    v_mul_f32 v25, v25, v28
    v_mul_f32 v28, -256.0, v16
    v_mul_f32 v29, 256.0, v17
    v_exp_f32 v28, v28
    v_fract_f32 v29, v29
    v_cos_f32 v26, v29
    v_sin_f32 v27, v29
    s_nop 0
    v_mul_f32 v26, v26, v28
    v_mul_f32 v27, v27, v28
    s_waitcnt lgkmcnt(0)
    v_cvt_pk_bf16_f32 v50, v18, -v19
    v_mov_b32 v51, 0x3f80
    v_cvt_pk_bf16_f32 v52, v22, v23
    ds_write_b32 v9, v50 offset:8704
    ds_write_b32 v9, v51
    ds_write_b32 v9, v52 offset:272
    v_pk_mul_f32 v[30:31], v[18:19], v[20:21] op_sel_hi:[1,0]
    v_pk_fma_f32 v[30:31], v[18:19], v[20:21], v[30:31] op_sel:[1,1,0] op_sel_hi:[0,1,1] neg_lo:[1,0,0]
    v_cvt_pk_bf16_f32 v50, v30, -v31
    v_cvt_pk_bf16_f32 v51, v24, v25
    ds_write_b32 v9, v50 offset:8976
    ds_write_b32 v9, v51 offset:544
    v_pk_mul_f32 v[32:33], v[30:31], v[20:21] op_sel_hi:[1,0]
    v_pk_mul_f32 v[48:49], v[22:23], v[24:25] op_sel_hi:[1,0]
    v_pk_mul_f32 v[42:43], v[24:25], v[24:25] op_sel_hi:[1,0]
    v_pk_fma_f32 v[32:33], v[30:31], v[20:21], v[32:33] op_sel:[1,1,0] op_sel_hi:[0,1,1] neg_lo:[1,0,0]
    v_pk_fma_f32 v[48:49], v[22:23], v[24:25], v[48:49] op_sel:[1,1,0] op_sel_hi:[0,1,1] neg_lo:[1,0,0]
    v_pk_fma_f32 v[42:43], v[24:25], v[24:25], v[42:43] op_sel:[1,1,0] op_sel_hi:[0,1,1] neg_lo:[1,0,0]
    v_cvt_pk_bf16_f32 v50, v32, -v33
    v_cvt_pk_bf16_f32 v52, v48, v49
    v_cvt_pk_bf16_f32 v51, v42, v43
    ds_write_b32 v9, v50 offset:9248
    ds_write_b32 v9, v52 offset:816
    ds_write_b32 v9, v51 offset:1088
    v_pk_mul_f32 v[30:31], v[32:33], v[20:21] op_sel_hi:[1,0]
    v_pk_mul_f32 v[46:47], v[48:49], v[24:25] op_sel_hi:[1,0]
    v_pk_fma_f32 v[30:31], v[32:33], v[20:21], v[30:31] op_sel:[1,1,0] op_sel_hi:[0,1,1] neg_lo:[1,0,0]
    v_pk_fma_f32 v[46:47], v[48:49], v[24:25], v[46:47] op_sel:[1,1,0] op_sel_hi:[0,1,1] neg_lo:[1,0,0]
    v_cvt_pk_bf16_f32 v50, v30, -v31
    v_cvt_pk_bf16_f32 v52, v46, v47
    ds_write_b32 v9, v50 offset:9520
    ds_write_b32 v9, v52 offset:1360
    v_pk_mul_f32 v[34:35], v[30:31], v[20:21] op_sel_hi:[1,0]
    v_pk_mul_f32 v[44:45], v[42:43], v[24:25] op_sel_hi:[1,0]
    v_pk_mul_f32 v[48:49], v[46:47], v[24:25] op_sel_hi:[1,0]
    v_pk_fma_f32 v[34:35], v[30:31], v[20:21], v[34:35] op_sel:[1,1,0] op_sel_hi:[0,1,1] neg_lo:[1,0,0]
    v_pk_fma_f32 v[44:45], v[42:43], v[24:25], v[44:45] op_sel:[1,1,0] op_sel_hi:[0,1,1] neg_lo:[1,0,0]
    v_pk_fma_f32 v[48:49], v[46:47], v[24:25], v[48:49] op_sel:[1,1,0] op_sel_hi:[0,1,1] neg_lo:[1,0,0]
    v_cvt_pk_bf16_f32 v50, v34, -v35
    v_cvt_pk_bf16_f32 v51, v44, v45
    v_cvt_pk_bf16_f32 v52, v48, v49
    ds_write_b32 v9, v50 offset:9792
    ds_write_b32 v9, v51 offset:1632
    ds_write_b32 v9, v52 offset:1904
    v_pk_mul_f32 v[30:31], v[34:35], v[20:21] op_sel_hi:[1,0]
    v_pk_mul_f32 v[42:43], v[44:45], v[24:25] op_sel_hi:[1,0]
    v_pk_fma_f32 v[30:31], v[34:35], v[20:21], v[30:31] op_sel:[1,1,0] op_sel_hi:[0,1,1] neg_lo:[1,0,0]
    v_pk_fma_f32 v[42:43], v[44:45], v[24:25], v[42:43] op_sel:[1,1,0] op_sel_hi:[0,1,1] neg_lo:[1,0,0]
    v_cvt_pk_bf16_f32 v50, v30, -v31
    v_cvt_pk_bf16_f32 v51, v42, v43
    ds_write_b32 v9, v50 offset:10064
    ds_write_b32 v9, v51 offset:2176
    v_pk_mul_f32 v[36:37], v[30:31], v[20:21] op_sel_hi:[1,0]
    v_pk_mul_f32 v[46:47], v[48:49], v[24:25] op_sel_hi:[1,0]
    v_pk_mul_f32 v[44:45], v[42:43], v[24:25] op_sel_hi:[1,0]
    v_pk_fma_f32 v[36:37], v[30:31], v[20:21], v[36:37] op_sel:[1,1,0] op_sel_hi:[0,1,1] neg_lo:[1,0,0]
    v_pk_fma_f32 v[46:47], v[48:49], v[24:25], v[46:47] op_sel:[1,1,0] op_sel_hi:[0,1,1] neg_lo:[1,0,0]
    v_pk_fma_f32 v[44:45], v[42:43], v[24:25], v[44:45] op_sel:[1,1,0] op_sel_hi:[0,1,1] neg_lo:[1,0,0]
    v_cvt_pk_bf16_f32 v50, v36, -v37
    v_cvt_pk_bf16_f32 v52, v46, v47
    v_cvt_pk_bf16_f32 v51, v44, v45
    ds_write_b32 v9, v50 offset:10336
    ds_write_b32 v9, v52 offset:2448
    ds_write_b32 v9, v51 offset:2720
    v_pk_mul_f32 v[30:31], v[36:37], v[20:21] op_sel_hi:[1,0]
    v_pk_mul_f32 v[48:49], v[46:47], v[24:25] op_sel_hi:[1,0]
    v_pk_fma_f32 v[30:31], v[36:37], v[20:21], v[30:31] op_sel:[1,1,0] op_sel_hi:[0,1,1] neg_lo:[1,0,0]
    v_pk_fma_f32 v[48:49], v[46:47], v[24:25], v[48:49] op_sel:[1,1,0] op_sel_hi:[0,1,1] neg_lo:[1,0,0]
    v_cvt_pk_bf16_f32 v50, v30, -v31
    v_cvt_pk_bf16_f32 v52, v48, v49
    ds_write_b32 v9, v50 offset:10608
    ds_write_b32 v9, v52 offset:2992
    v_pk_mul_f32 v[38:39], v[18:19], v[26:27] op_sel_hi:[1,0]
    v_pk_mul_f32 v[42:43], v[44:45], v[24:25] op_sel_hi:[1,0]
    v_pk_mul_f32 v[46:47], v[48:49], v[24:25] op_sel_hi:[1,0]
    v_pk_fma_f32 v[38:39], v[18:19], v[26:27], v[38:39] op_sel:[1,1,0] op_sel_hi:[0,1,1] neg_lo:[1,0,0]
    v_pk_fma_f32 v[42:43], v[44:45], v[24:25], v[42:43] op_sel:[1,1,0] op_sel_hi:[0,1,1] neg_lo:[1,0,0]
    v_pk_fma_f32 v[46:47], v[48:49], v[24:25], v[46:47] op_sel:[1,1,0] op_sel_hi:[0,1,1] neg_lo:[1,0,0]
    v_cvt_pk_bf16_f32 v50, v38, -v39
    v_cvt_pk_bf16_f32 v51, v42, v43
    v_cvt_pk_bf16_f32 v52, v46, v47
    ds_write_b32 v9, v50 offset:10880
    ds_write_b32 v9, v51 offset:3264
    ds_write_b32 v9, v52 offset:3536
    v_pk_mul_f32 v[30:31], v[32:33], v[26:27] op_sel_hi:[1,0]
    v_pk_mul_f32 v[44:45], v[42:43], v[24:25] op_sel_hi:[1,0]
    v_pk_fma_f32 v[30:31], v[32:33], v[26:27], v[30:31] op_sel:[1,1,0] op_sel_hi:[0,1,1] neg_lo:[1,0,0]
    v_pk_fma_f32 v[44:45], v[42:43], v[24:25], v[44:45] op_sel:[1,1,0] op_sel_hi:[0,1,1] neg_lo:[1,0,0]
    v_cvt_pk_bf16_f32 v50, v30, -v31
    v_cvt_pk_bf16_f32 v51, v44, v45
    ds_write_b32 v9, v50 offset:11152
    ds_write_b32 v9, v51 offset:3808
    v_pk_mul_f32 v[40:41], v[34:35], v[26:27] op_sel_hi:[1,0]
    v_pk_mul_f32 v[48:49], v[46:47], v[24:25] op_sel_hi:[1,0]
    v_pk_mul_f32 v[42:43], v[44:45], v[24:25] op_sel_hi:[1,0]
    v_pk_fma_f32 v[40:41], v[34:35], v[26:27], v[40:41] op_sel:[1,1,0] op_sel_hi:[0,1,1] neg_lo:[1,0,0]
    v_pk_fma_f32 v[48:49], v[46:47], v[24:25], v[48:49] op_sel:[1,1,0] op_sel_hi:[0,1,1] neg_lo:[1,0,0]
    v_pk_fma_f32 v[42:43], v[44:45], v[24:25], v[42:43] op_sel:[1,1,0] op_sel_hi:[0,1,1] neg_lo:[1,0,0]
    v_cvt_pk_bf16_f32 v50, v40, -v41
    v_cvt_pk_bf16_f32 v52, v48, v49
    v_cvt_pk_bf16_f32 v51, v42, v43
    ds_write_b32 v9, v50 offset:11424
    ds_write_b32 v9, v52 offset:4080
    ds_write_b32 v9, v51 offset:4352
    v_pk_mul_f32 v[30:31], v[36:37], v[26:27] op_sel_hi:[1,0]
    v_pk_mul_f32 v[46:47], v[48:49], v[24:25] op_sel_hi:[1,0]
    v_pk_fma_f32 v[30:31], v[36:37], v[26:27], v[30:31] op_sel:[1,1,0] op_sel_hi:[0,1,1] neg_lo:[1,0,0]
    v_pk_fma_f32 v[46:47], v[48:49], v[24:25], v[46:47] op_sel:[1,1,0] op_sel_hi:[0,1,1] neg_lo:[1,0,0]
    v_cvt_pk_bf16_f32 v50, v30, -v31
    v_cvt_pk_bf16_f32 v52, v46, v47
    ds_write_b32 v9, v50 offset:11696
    ds_write_b32 v9, v52 offset:4624
    v_pk_mul_f32 v[32:33], v[38:39], v[26:27] op_sel_hi:[1,0]
    v_pk_mul_f32 v[44:45], v[42:43], v[24:25] op_sel_hi:[1,0]
    v_pk_mul_f32 v[48:49], v[46:47], v[24:25] op_sel_hi:[1,0]
    v_pk_fma_f32 v[32:33], v[38:39], v[26:27], v[32:33] op_sel:[1,1,0] op_sel_hi:[0,1,1] neg_lo:[1,0,0]
    v_pk_fma_f32 v[44:45], v[42:43], v[24:25], v[44:45] op_sel:[1,1,0] op_sel_hi:[0,1,1] neg_lo:[1,0,0]
    v_pk_fma_f32 v[48:49], v[46:47], v[24:25], v[48:49] op_sel:[1,1,0] op_sel_hi:[0,1,1] neg_lo:[1,0,0]
    v_cvt_pk_bf16_f32 v50, v32, -v33
    v_cvt_pk_bf16_f32 v51, v44, v45
    v_cvt_pk_bf16_f32 v52, v48, v49
    ds_write_b32 v9, v50 offset:11968
    ds_write_b32 v9, v51 offset:4896
    ds_write_b32 v9, v52 offset:5168
    v_pk_mul_f32 v[34:35], v[40:41], v[26:27] op_sel_hi:[1,0]
    v_pk_mul_f32 v[42:43], v[44:45], v[24:25] op_sel_hi:[1,0]
    v_pk_fma_f32 v[34:35], v[40:41], v[26:27], v[34:35] op_sel:[1,1,0] op_sel_hi:[0,1,1] neg_lo:[1,0,0]
    v_pk_fma_f32 v[42:43], v[44:45], v[24:25], v[42:43] op_sel:[1,1,0] op_sel_hi:[0,1,1] neg_lo:[1,0,0]
    v_cvt_pk_bf16_f32 v50, v34, -v35
    v_cvt_pk_bf16_f32 v51, v42, v43
    ds_write_b32 v9, v50 offset:12240
    ds_write_b32 v9, v51 offset:5440
    v_pk_mul_f32 v[36:37], v[32:33], v[26:27] op_sel_hi:[1,0]
    v_pk_mul_f32 v[46:47], v[48:49], v[24:25] op_sel_hi:[1,0]
    v_pk_mul_f32 v[44:45], v[42:43], v[24:25] op_sel_hi:[1,0]
    v_pk_fma_f32 v[36:37], v[32:33], v[26:27], v[36:37] op_sel:[1,1,0] op_sel_hi:[0,1,1] neg_lo:[1,0,0]
    v_pk_fma_f32 v[46:47], v[48:49], v[24:25], v[46:47] op_sel:[1,1,0] op_sel_hi:[0,1,1] neg_lo:[1,0,0]
    v_pk_fma_f32 v[44:45], v[42:43], v[24:25], v[44:45] op_sel:[1,1,0] op_sel_hi:[0,1,1] neg_lo:[1,0,0]
    v_cvt_pk_bf16_f32 v50, v36, -v37
    v_cvt_pk_bf16_f32 v52, v46, v47
    v_cvt_pk_bf16_f32 v51, v44, v45
    ds_write_b32 v9, v50 offset:12512
    ds_write_b32 v9, v52 offset:5712
    ds_write_b32 v9, v51 offset:5984
    v_pk_mul_f32 v[30:31], v[34:35], v[26:27] op_sel_hi:[1,0]
    v_pk_mul_f32 v[48:49], v[46:47], v[24:25] op_sel_hi:[1,0]
    v_pk_fma_f32 v[30:31], v[34:35], v[26:27], v[30:31] op_sel:[1,1,0] op_sel_hi:[0,1,1] neg_lo:[1,0,0]
    v_pk_fma_f32 v[48:49], v[46:47], v[24:25], v[48:49] op_sel:[1,1,0] op_sel_hi:[0,1,1] neg_lo:[1,0,0]
    v_cvt_pk_bf16_f32 v50, v30, -v31
    v_cvt_pk_bf16_f32 v52, v48, v49
    ds_write_b32 v9, v50 offset:12784
    ds_write_b32 v9, v52 offset:6256
    v_pk_mul_f32 v[38:39], v[36:37], v[26:27] op_sel_hi:[1,0]
    v_pk_mul_f32 v[42:43], v[44:45], v[24:25] op_sel_hi:[1,0]
    v_pk_mul_f32 v[46:47], v[48:49], v[24:25] op_sel_hi:[1,0]
    v_pk_fma_f32 v[38:39], v[36:37], v[26:27], v[38:39] op_sel:[1,1,0] op_sel_hi:[0,1,1] neg_lo:[1,0,0]
    v_pk_fma_f32 v[42:43], v[44:45], v[24:25], v[42:43] op_sel:[1,1,0] op_sel_hi:[0,1,1] neg_lo:[1,0,0]
    v_pk_fma_f32 v[46:47], v[48:49], v[24:25], v[46:47] op_sel:[1,1,0] op_sel_hi:[0,1,1] neg_lo:[1,0,0]
    v_cvt_pk_bf16_f32 v50, v38, -v39
    v_cvt_pk_bf16_f32 v51, v42, v43
    v_cvt_pk_bf16_f32 v52, v46, v47
    ds_write_b32 v9, v50 offset:13056
    ds_write_b32 v9, v51 offset:6528
    ds_write_b32 v9, v52 offset:6800
    v_pk_mul_f32 v[40:41], v[38:39], v[26:27] op_sel_hi:[1,0]
    v_pk_mul_f32 v[44:45], v[42:43], v[24:25] op_sel_hi:[1,0]
    v_pk_fma_f32 v[40:41], v[38:39], v[26:27], v[40:41] op_sel:[1,1,0] op_sel_hi:[0,1,1] neg_lo:[1,0,0]
    v_pk_fma_f32 v[44:45], v[42:43], v[24:25], v[44:45] op_sel:[1,1,0] op_sel_hi:[0,1,1] neg_lo:[1,0,0]
    v_cvt_pk_bf16_f32 v50, v40, -v41
    v_cvt_pk_bf16_f32 v51, v44, v45
    ds_write_b32 v9, v50 offset:13328
    ds_write_b32 v9, v51 offset:7072
    v_pk_mul_f32 v[38:39], v[40:41], v[26:27] op_sel_hi:[1,0]
    v_pk_mul_f32 v[48:49], v[46:47], v[24:25] op_sel_hi:[1,0]
    v_pk_mul_f32 v[42:43], v[44:45], v[24:25] op_sel_hi:[1,0]
    v_pk_fma_f32 v[38:39], v[40:41], v[26:27], v[38:39] op_sel:[1,1,0] op_sel_hi:[0,1,1] neg_lo:[1,0,0]
    v_pk_fma_f32 v[48:49], v[46:47], v[24:25], v[48:49] op_sel:[1,1,0] op_sel_hi:[0,1,1] neg_lo:[1,0,0]
    v_pk_fma_f32 v[42:43], v[44:45], v[24:25], v[42:43] op_sel:[1,1,0] op_sel_hi:[0,1,1] neg_lo:[1,0,0]
    v_cvt_pk_bf16_f32 v50, v38, -v39
    v_cvt_pk_bf16_f32 v52, v48, v49
    v_cvt_pk_bf16_f32 v51, v42, v43
    ds_write_b32 v9, v50 offset:13600
    ds_write_b32 v9, v52 offset:7344
    ds_write_b32 v9, v51 offset:7616
    v_pk_mul_f32 v[40:41], v[38:39], v[26:27] op_sel_hi:[1,0]
    v_pk_mul_f32 v[46:47], v[48:49], v[24:25] op_sel_hi:[1,0]
    v_pk_fma_f32 v[40:41], v[38:39], v[26:27], v[40:41] op_sel:[1,1,0] op_sel_hi:[0,1,1] neg_lo:[1,0,0]
    v_pk_fma_f32 v[46:47], v[48:49], v[24:25], v[46:47] op_sel:[1,1,0] op_sel_hi:[0,1,1] neg_lo:[1,0,0]
    v_cvt_pk_bf16_f32 v50, v40, -v41
    v_cvt_pk_bf16_f32 v52, v46, v47
    ds_write_b32 v9, v50 offset:13872
    ds_write_b32 v9, v52 offset:7888
    v_pk_mul_f32 v[38:39], v[40:41], v[26:27] op_sel_hi:[1,0]
    v_pk_mul_f32 v[44:45], v[42:43], v[24:25] op_sel_hi:[1,0]
    v_pk_mul_f32 v[48:49], v[46:47], v[24:25] op_sel_hi:[1,0]
    v_pk_fma_f32 v[38:39], v[40:41], v[26:27], v[38:39] op_sel:[1,1,0] op_sel_hi:[0,1,1] neg_lo:[1,0,0]
    v_pk_fma_f32 v[44:45], v[42:43], v[24:25], v[44:45] op_sel:[1,1,0] op_sel_hi:[0,1,1] neg_lo:[1,0,0]
    v_pk_fma_f32 v[48:49], v[46:47], v[24:25], v[48:49] op_sel:[1,1,0] op_sel_hi:[0,1,1] neg_lo:[1,0,0]
    v_cvt_pk_bf16_f32 v50, v38, -v39
    v_cvt_pk_bf16_f32 v51, v44, v45
    v_cvt_pk_bf16_f32 v52, v48, v49
    ds_write_b32 v9, v50 offset:14144
    ds_write_b32 v9, v51 offset:8160
    ds_write_b32 v9, v52 offset:8432
    s_waitcnt lgkmcnt(0)
    ds_read_b128 v[80:83], v12 offset:0
    ds_read_b128 v[84:87], v13 offset:0
    ds_read_b128 v[88:91], v12 offset:32
    ds_read_b128 v[92:95], v13 offset:32
    ds_read_b128 v[96:99], v12 offset:64
    ds_read_b128 v[100:103], v13 offset:64
    ds_read_b128 v[104:107], v12 offset:96
    ds_read_b128 v[108:111], v13 offset:96
    s_waitcnt lgkmcnt(6)
    v_mfma_f32_32x32x16_bf16 v[64:79], v[80:83], v[84:87], v[64:79]
    s_waitcnt lgkmcnt(4)
    v_mfma_f32_32x32x16_bf16 v[64:79], v[88:91], v[92:95], v[64:79]
    s_waitcnt lgkmcnt(2)
    v_mfma_f32_32x32x16_bf16 v[64:79], v[96:99], v[100:103], v[64:79]
    s_waitcnt lgkmcnt(0)
    v_mfma_f32_32x32x16_bf16 v[64:79], v[104:107], v[108:111], v[64:79]
    ds_read_b128 v[80:83], v12 offset:128
    ds_read_b128 v[84:87], v13 offset:128
    ds_read_b128 v[88:91], v12 offset:160
    ds_read_b128 v[92:95], v13 offset:160
    ds_read_b128 v[96:99], v12 offset:192
    ds_read_b128 v[100:103], v13 offset:192
    ds_read_b128 v[104:107], v12 offset:224
    ds_read_b128 v[108:111], v13 offset:224
    s_waitcnt lgkmcnt(6)
    v_mfma_f32_32x32x16_bf16 v[64:79], v[80:83], v[84:87], v[64:79]
    s_waitcnt lgkmcnt(4)
    v_mfma_f32_32x32x16_bf16 v[64:79], v[88:91], v[92:95], v[64:79]
    s_waitcnt lgkmcnt(2)
    v_mfma_f32_32x32x16_bf16 v[64:79], v[96:99], v[100:103], v[64:79]
    s_waitcnt lgkmcnt(0)
    v_mfma_f32_32x32x16_bf16 v[64:79], v[104:107], v[108:111], v[64:79]
    s_sub_u32 s47, s47, 1
    s_cmp_lg_u32 s47, 0
    s_cbranch_scc1 A_loop
    v_lshlrev_b32 v16, 4, v10
    v_lshl_add_u32 v16, v11, 3, v16
    v_add_u32 v16, s7, v16
    v_lshlrev_b32 v17, 3, v10
    v_add_u32 v17, 512, v17
    v_lshlrev_b32 v18, 2, v10
    v_add_u32 v18, 768, v18
    v_add_u32 v19, 4, v17
    v_add_u32 v20, 128, v18
    v_cmp_eq_u32 vcc, 1, v11
    s_nop 1
    v_cndmask_b32 v17, v17, v18, vcc
    v_cndmask_b32 v19, v19, v20, vcc
    v_add_u32 v17, s7, v17
    v_add_u32 v19, s7, v19
    v_lshlrev_b32 v18, 1, v10
    v_lshl_add_u32 v18, v11, 8, v18
    v_add_u32 v18, s7, v18
    s_nop 4
    v_cvt_pk_bf16_f32 v22, v64, v65
    v_cvt_pk_bf16_f32 v23, v66, v67
    v_cvt_pk_bf16_f32 v24, v68, v69
    v_cvt_pk_bf16_f32 v25, v70, v71
    v_cvt_pk_bf16_f32 v26, v72, v73
    v_cvt_pk_bf16_f32 v27, v74, v75
    ds_write_b64 v16, v[22:23]
    ds_write_b32 v17, v24
    ds_write_b32 v19, v25
    ds_write_b16 v18, v26 offset:1024
    ds_write_b16_d16_hi v18, v26 offset:1088
    ds_write_b16 v18, v27 offset:1152
    ds_write_b16_d16_hi v18, v27 offset:1216
    v_lshlrev_b32 v15, 3, v0
    v_sub_u32 v15, 2047, v15
    v_cvt_f32_u32 v14, v15
    s_sub_u32 s46, s7, 34048
    v_mov_b32 v12, s46
    v_mov_b32 v13, 2
    v_lshlrev_b32 v1, 4, v0
    s_waitcnt lgkmcnt(0)
    v_subrev_f32 v30, 0.0, v14
    v_subrev_f32 v31, 1.0, v14
    v_cvt_pk_bf16_f32 v30, v30, v31
    v_mad_u32_u16 v32, v30, v13, v12
    v_mad_u32_u16 v33, v30, v13, v12 op_sel:[1,0,0,0]
    ds_read_u16 v64, v32
    ds_read_u16 v65, v33
    v_subrev_f32 v30, 2.0, v14
    v_subrev_f32 v31, 3.0, v14
    v_cvt_pk_bf16_f32 v30, v30, v31
    v_mad_u32_u16 v32, v30, v13, v12
    v_mad_u32_u16 v33, v30, v13, v12 op_sel:[1,0,0,0]
    ds_read_u16 v66, v32
    ds_read_u16 v67, v33
    v_subrev_f32 v30, 4.0, v14
    v_subrev_f32 v31, 5.0, v14
    v_cvt_pk_bf16_f32 v30, v30, v31
    v_mad_u32_u16 v32, v30, v13, v12
    v_mad_u32_u16 v33, v30, v13, v12 op_sel:[1,0,0,0]
    ds_read_u16 v68, v32
    ds_read_u16 v69, v33
    v_subrev_f32 v30, 6.0, v14
    v_subrev_f32 v31, 7.0, v14
    v_cvt_pk_bf16_f32 v30, v30, v31
    v_mad_u32_u16 v32, v30, v13, v12
    v_mad_u32_u16 v33, v30, v13, v12 op_sel:[1,0,0,0]
    ds_read_u16 v70, v32
    ds_read_u16 v71, v33
    v_subrev_f32 v30, 512.0, v14
    v_subrev_f32 v31, 513.0, v14
    v_cvt_pk_bf16_f32 v30, v30, v31
    v_mad_u32_u16 v32, v30, v13, v12
    v_mad_u32_u16 v33, v30, v13, v12 op_sel:[1,0,0,0]
    ds_read_u16 v72, v32
    ds_read_u16 v73, v33
    v_subrev_f32 v30, 514.0, v14
    v_subrev_f32 v31, 515.0, v14
    v_cvt_pk_bf16_f32 v30, v30, v31
    v_mad_u32_u16 v32, v30, v13, v12
    v_mad_u32_u16 v33, v30, v13, v12 op_sel:[1,0,0,0]
    ds_read_u16 v74, v32
    ds_read_u16 v75, v33
    v_subrev_f32 v30, 516.0, v14
    v_subrev_f32 v31, 517.0, v14
    v_cvt_pk_bf16_f32 v30, v30, v31
    v_mad_u32_u16 v32, v30, v13, v12
    v_mad_u32_u16 v33, v30, v13, v12 op_sel:[1,0,0,0]
    ds_read_u16 v76, v32
    ds_read_u16 v77, v33
    v_subrev_f32 v30, 518.0, v14
    v_subrev_f32 v31, 519.0, v14
    v_cvt_pk_bf16_f32 v30, v30, v31
    v_mad_u32_u16 v32, v30, v13, v12
    v_mad_u32_u16 v33, v30, v13, v12 op_sel:[1,0,0,0]
    ds_read_u16 v78, v32
    ds_read_u16 v79, v33
    s_waitcnt lgkmcnt(8)
    v_lshl_or_b32 v40, v65, 16, v64
    v_lshl_or_b32 v41, v67, 16, v66
    v_lshl_or_b32 v42, v69, 16, v68
    v_lshl_or_b32 v43, v71, 16, v70
    buffer_store_dwordx4 v[40:43], v1, s[40:43], 0 offen offset:0 sc0 sc1
    v_subrev_f32 v30, 1024.0, v14
    v_subrev_f32 v31, 1025.0, v14
    v_cvt_pk_bf16_f32 v30, v30, v31
    v_mad_u32_u16 v32, v30, v13, v12
    v_mad_u32_u16 v33, v30, v13, v12 op_sel:[1,0,0,0]
    ds_read_u16 v80, v32
    ds_read_u16 v81, v33
    v_subrev_f32 v30, 1026.0, v14
    v_subrev_f32 v31, 1027.0, v14
    v_cvt_pk_bf16_f32 v30, v30, v31
    v_mad_u32_u16 v32, v30, v13, v12
    v_mad_u32_u16 v33, v30, v13, v12 op_sel:[1,0,0,0]
    ds_read_u16 v82, v32
    ds_read_u16 v83, v33
    v_subrev_f32 v30, 1028.0, v14
    v_subrev_f32 v31, 1029.0, v14
    v_cvt_pk_bf16_f32 v30, v30, v31
    v_mad_u32_u16 v32, v30, v13, v12
    v_mad_u32_u16 v33, v30, v13, v12 op_sel:[1,0,0,0]
    ds_read_u16 v84, v32
    ds_read_u16 v85, v33
    v_subrev_f32 v30, 1030.0, v14
    v_subrev_f32 v31, 1031.0, v14
    v_cvt_pk_bf16_f32 v30, v30, v31
    v_mad_u32_u16 v32, v30, v13, v12
    v_mad_u32_u16 v33, v30, v13, v12 op_sel:[1,0,0,0]
    ds_read_u16 v86, v32
    ds_read_u16 v87, v33
    s_waitcnt lgkmcnt(8)
    v_lshl_or_b32 v44, v73, 16, v72
    v_lshl_or_b32 v45, v75, 16, v74
    v_lshl_or_b32 v46, v77, 16, v76
    v_lshl_or_b32 v47, v79, 16, v78
    buffer_store_dwordx4 v[44:47], v1, s[40:43], 0 offen offset:1024 sc0 sc1
    v_subrev_f32 v30, 1536.0, v14
    v_subrev_f32 v31, 1537.0, v14
    v_cvt_pk_bf16_f32 v30, v30, v31
    v_mad_u32_u16 v32, v30, v13, v12
    v_mad_u32_u16 v33, v30, v13, v12 op_sel:[1,0,0,0]
    v_subrev_u32 v34, 1536, v15
    v_min_u32 v34, 0x80, v34
    v_lshl_add_u32 v34, v34, 1, s7
    v_max_i32 v32, v32, v34
    v_subrev_u32 v34, 1537, v15
    v_min_u32 v34, 0x80, v34
    v_lshl_add_u32 v34, v34, 1, s7
    v_max_i32 v33, v33, v34
    ds_read_u16 v88, v32
    ds_read_u16 v89, v33
    v_subrev_f32 v30, 1538.0, v14
    v_subrev_f32 v31, 1539.0, v14
    v_cvt_pk_bf16_f32 v30, v30, v31
    v_mad_u32_u16 v32, v30, v13, v12
    v_mad_u32_u16 v33, v30, v13, v12 op_sel:[1,0,0,0]
    v_subrev_u32 v34, 1538, v15
    v_min_u32 v34, 0x80, v34
    v_lshl_add_u32 v34, v34, 1, s7
    v_max_i32 v32, v32, v34
    v_subrev_u32 v34, 1539, v15
    v_min_u32 v34, 0x80, v34
    v_lshl_add_u32 v34, v34, 1, s7
    v_max_i32 v33, v33, v34
    ds_read_u16 v90, v32
    ds_read_u16 v91, v33
    v_subrev_f32 v30, 1540.0, v14
    v_subrev_f32 v31, 1541.0, v14
    v_cvt_pk_bf16_f32 v30, v30, v31
    v_mad_u32_u16 v32, v30, v13, v12
    v_mad_u32_u16 v33, v30, v13, v12 op_sel:[1,0,0,0]
    v_subrev_u32 v34, 1540, v15
    v_min_u32 v34, 0x80, v34
    v_lshl_add_u32 v34, v34, 1, s7
    v_max_i32 v32, v32, v34
    v_subrev_u32 v34, 1541, v15
    v_min_u32 v34, 0x80, v34
    v_lshl_add_u32 v34, v34, 1, s7
    v_max_i32 v33, v33, v34
    ds_read_u16 v92, v32
    ds_read_u16 v93, v33
    v_subrev_f32 v30, 1542.0, v14
    v_subrev_f32 v31, 1543.0, v14
    v_cvt_pk_bf16_f32 v30, v30, v31
    v_mad_u32_u16 v32, v30, v13, v12
    v_mad_u32_u16 v33, v30, v13, v12 op_sel:[1,0,0,0]
    v_subrev_u32 v34, 1542, v15
    v_min_u32 v34, 0x80, v34
    v_lshl_add_u32 v34, v34, 1, s7
    v_max_i32 v32, v32, v34
    v_subrev_u32 v34, 1543, v15
    v_min_u32 v34, 0x80, v34
    v_lshl_add_u32 v34, v34, 1, s7
    v_max_i32 v33, v33, v34
    ds_read_u16 v94, v32
    ds_read_u16 v95, v33
    s_waitcnt lgkmcnt(8)
    v_lshl_or_b32 v48, v81, 16, v80
    v_lshl_or_b32 v49, v83, 16, v82
    v_lshl_or_b32 v50, v85, 16, v84
    v_lshl_or_b32 v51, v87, 16, v86
    buffer_store_dwordx4 v[48:51], v1, s[40:43], 0 offen offset:2048 sc0 sc1
    s_waitcnt lgkmcnt(0)
    v_lshl_or_b32 v52, v89, 16, v88
    v_lshl_or_b32 v53, v91, 16, v90
    v_lshl_or_b32 v54, v93, 16, v92
    v_lshl_or_b32 v55, v95, 16, v94
    buffer_store_dwordx4 v[52:55], v1, s[40:43], 0 offen offset:3072 sc0 sc1
    s_endpgm
A_x:
    s_load_dwordx2 s[8:9], s[0:1], 0
    s_load_dwordx2 s[10:11], s[0:1], 120
    s_setprio 3
    s_sub_u32 s4, s2, 192
    s_lshr_b32 s5, s4, 4
    s_lshl_b32 s5, s5, 9
    s_and_b32 s6, s4, 3
    s_lshl_b32 s6, s6, 6
    s_add_u32 s5, s5, s6
    s_bfe_u32 s6, s4, 0x20002
    s_lshl_b32 s6, s6, 2
    s_add_u32 s5, s5, s6
    s_mul_i32 s5, s5, 1280
    v_lshrrev_b32 v3, 6, v0
    v_lshlrev_b32 v3, 4, v3
    v_bfe_u32 v4, v0, 5, 1
    v_lshl_add_u32 v3, v4, 8, v3
    v_bfe_u32 v14, v0, 3, 2
    v_add_u32 v3, v3, v14
    v_lshlrev_b32 v15, 8, v4
    v_lshrrev_b32 v4, 6, v0
    v_lshl_add_u32 v15, v4, 2, v15
    v_add_lshl_u32 v15, v15, v14, 2
    v_lshrrev_b32 v1, 3, v0
    v_and_b32 v2, 7, v0
    v_lshlrev_b32 v2, 4, v2
    v_mul_u32_u24 v3, 1280, v3
    v_add_u32 v3, v3, v2
    v_mul_u32_u24 v4, 1296, v1
    v_add_u32 v4, v4, v2
    s_waitcnt lgkmcnt(0)
    s_mov_b32 s12, s8
    s_mov_b32 s13, s9
    s_mov_b32 s14, 0x280000
    s_mov_b32 s15, 0x00020000
    s_mov_b32 s16, s10
    s_mov_b32 s17, s11
    s_mov_b32 s18, 0x280000
    s_mov_b32 s19, 0x00020000
    s_add_u32 s20, s10, 0x780000
    s_addc_u32 s21, s11, 0
    s_mov_b32 s22, 0xa000
    s_mov_b32 s23, 0x00020000
    buffer_load_dwordx4 v[16:19], v3, s[12:15], s5 offen offset:0
    buffer_load_dwordx4 v[20:23], v3, s[12:15], s5 offen offset:128
    buffer_load_dwordx4 v[24:27], v3, s[12:15], s5 offen offset:256
    buffer_load_dwordx4 v[28:31], v3, s[12:15], s5 offen offset:384
    buffer_load_dwordx4 v[32:35], v3, s[12:15], s5 offen offset:512
    buffer_load_dwordx4 v[36:39], v3, s[12:15], s5 offen offset:640
    buffer_load_dwordx4 v[40:43], v3, s[12:15], s5 offen offset:768
    buffer_load_dwordx4 v[44:47], v3, s[12:15], s5 offen offset:896
    buffer_load_dwordx4 v[48:51], v3, s[12:15], s5 offen offset:1024
    buffer_load_dwordx4 v[52:55], v3, s[12:15], s5 offen offset:1152
    s_mov_b32 s24, 0x3f803f80
    v_mov_b32 v5, 0
    v_mov_b32 v6, 0
    v_and_b32 v7, 63, v0
    v_lshrrev_b32 v8, 6, v0
    v_lshrrev_b32 v9, 4, v7
    v_bfe_u32 v10, v7, 2, 2
    v_and_b32 v11, 3, v7
    v_lshl_add_u32 v12, v11, 3, v10
    v_mul_u32_u24 v12, 1296, v12
    v_lshl_add_u32 v12, v9, 3, v12
    v_lshl_add_u32 v12, v8, 5, v12
    v_lshl_add_u32 v13, v8, 2, v9
    v_lshlrev_b32 v13, 14, v13
    v_and_b32 v9, 15, v7
    v_lshl_add_u32 v13, v9, 4, v13
    s_lshl_b32 s6, s4, 8
    s_waitcnt vmcnt(9)
    ds_write_b128 v4, v[16:19] offset:0
    v_dot2c_f32_bf16 v5, s24, v16
    v_dot2c_f32_bf16 v6, v16, v16
    v_dot2c_f32_bf16 v5, s24, v17
    v_dot2c_f32_bf16 v6, v17, v17
    v_dot2c_f32_bf16 v5, s24, v18
    v_dot2c_f32_bf16 v6, v18, v18
    v_dot2c_f32_bf16 v5, s24, v19
    v_dot2c_f32_bf16 v6, v19, v19
    s_waitcnt vmcnt(8)
    ds_write_b128 v4, v[20:23] offset:128
    v_dot2c_f32_bf16 v5, s24, v20
    v_dot2c_f32_bf16 v6, v20, v20
    v_dot2c_f32_bf16 v5, s24, v21
    v_dot2c_f32_bf16 v6, v21, v21
    v_dot2c_f32_bf16 v5, s24, v22
    v_dot2c_f32_bf16 v6, v22, v22
    v_dot2c_f32_bf16 v5, s24, v23
    v_dot2c_f32_bf16 v6, v23, v23
    s_waitcnt vmcnt(7)
    ds_write_b128 v4, v[24:27] offset:256
    v_dot2c_f32_bf16 v5, s24, v24
    v_dot2c_f32_bf16 v6, v24, v24
    v_dot2c_f32_bf16 v5, s24, v25
    v_dot2c_f32_bf16 v6, v25, v25
    v_dot2c_f32_bf16 v5, s24, v26
    v_dot2c_f32_bf16 v6, v26, v26
    v_dot2c_f32_bf16 v5, s24, v27
    v_dot2c_f32_bf16 v6, v27, v27
    s_waitcnt vmcnt(6)
    ds_write_b128 v4, v[28:31] offset:384
    v_dot2c_f32_bf16 v5, s24, v28
    v_dot2c_f32_bf16 v6, v28, v28
    v_dot2c_f32_bf16 v5, s24, v29
    v_dot2c_f32_bf16 v6, v29, v29
    v_dot2c_f32_bf16 v5, s24, v30
    v_dot2c_f32_bf16 v6, v30, v30
    v_dot2c_f32_bf16 v5, s24, v31
    v_dot2c_f32_bf16 v6, v31, v31
    s_waitcnt vmcnt(5)
    ds_write_b128 v4, v[32:35] offset:512
    v_dot2c_f32_bf16 v5, s24, v32
    v_dot2c_f32_bf16 v6, v32, v32
    v_dot2c_f32_bf16 v5, s24, v33
    v_dot2c_f32_bf16 v6, v33, v33
    v_dot2c_f32_bf16 v5, s24, v34
    v_dot2c_f32_bf16 v6, v34, v34
    v_dot2c_f32_bf16 v5, s24, v35
    v_dot2c_f32_bf16 v6, v35, v35
    s_waitcnt vmcnt(4)
    ds_write_b128 v4, v[36:39] offset:640
    v_dot2c_f32_bf16 v5, s24, v36
    v_dot2c_f32_bf16 v6, v36, v36
    v_dot2c_f32_bf16 v5, s24, v37
    v_dot2c_f32_bf16 v6, v37, v37
    v_dot2c_f32_bf16 v5, s24, v38
    v_dot2c_f32_bf16 v6, v38, v38
    v_dot2c_f32_bf16 v5, s24, v39
    v_dot2c_f32_bf16 v6, v39, v39
    s_waitcnt vmcnt(3)
    ds_write_b128 v4, v[40:43] offset:768
    v_dot2c_f32_bf16 v5, s24, v40
    v_dot2c_f32_bf16 v6, v40, v40
    v_dot2c_f32_bf16 v5, s24, v41
    v_dot2c_f32_bf16 v6, v41, v41
    v_dot2c_f32_bf16 v5, s24, v42
    v_dot2c_f32_bf16 v6, v42, v42
    v_dot2c_f32_bf16 v5, s24, v43
    v_dot2c_f32_bf16 v6, v43, v43
    s_waitcnt vmcnt(2)
    ds_write_b128 v4, v[44:47] offset:896
    v_dot2c_f32_bf16 v5, s24, v44
    v_dot2c_f32_bf16 v6, v44, v44
    v_dot2c_f32_bf16 v5, s24, v45
    v_dot2c_f32_bf16 v6, v45, v45
    v_dot2c_f32_bf16 v5, s24, v46
    v_dot2c_f32_bf16 v6, v46, v46
    v_dot2c_f32_bf16 v5, s24, v47
    v_dot2c_f32_bf16 v6, v47, v47
    s_waitcnt vmcnt(1)
    ds_write_b128 v4, v[48:51] offset:1024
    v_dot2c_f32_bf16 v5, s24, v48
    v_dot2c_f32_bf16 v6, v48, v48
    v_dot2c_f32_bf16 v5, s24, v49
    v_dot2c_f32_bf16 v6, v49, v49
    v_dot2c_f32_bf16 v5, s24, v50
    v_dot2c_f32_bf16 v6, v50, v50
    v_dot2c_f32_bf16 v5, s24, v51
    v_dot2c_f32_bf16 v6, v51, v51
    s_waitcnt vmcnt(0)
    ds_write_b128 v4, v[52:55] offset:1152
    v_dot2c_f32_bf16 v5, s24, v52
    v_dot2c_f32_bf16 v6, v52, v52
    v_dot2c_f32_bf16 v5, s24, v53
    v_dot2c_f32_bf16 v6, v53, v53
    v_dot2c_f32_bf16 v5, s24, v54
    v_dot2c_f32_bf16 v6, v54, v54
    v_dot2c_f32_bf16 v5, s24, v55
    v_dot2c_f32_bf16 v6, v55, v55
    s_waitcnt lgkmcnt(0)
    s_barrier
    ds_read_b64_tr_b16 v[16:17], v12 offset:0
    ds_read_b64_tr_b16 v[18:19], v12 offset:5184
    ds_read_b64_tr_b16 v[20:21], v12 offset:128
    ds_read_b64_tr_b16 v[22:23], v12 offset:5312
    ds_read_b64_tr_b16 v[24:25], v12 offset:256
    ds_read_b64_tr_b16 v[26:27], v12 offset:5440
    ds_read_b64_tr_b16 v[28:29], v12 offset:384
    ds_read_b64_tr_b16 v[30:31], v12 offset:5568
    ds_read_b64_tr_b16 v[32:33], v12 offset:512
    ds_read_b64_tr_b16 v[34:35], v12 offset:5696
    ds_read_b64_tr_b16 v[36:37], v12 offset:640
    ds_read_b64_tr_b16 v[38:39], v12 offset:5824
    s_waitcnt lgkmcnt(10)
    buffer_store_dwordx4 v[16:19], v13, s[16:19], s6 offen sc0 sc1
    s_add_u32 s6, s6, 0x40000
    ds_read_b64_tr_b16 v[40:41], v12 offset:768
    ds_read_b64_tr_b16 v[42:43], v12 offset:5952
    s_waitcnt lgkmcnt(10)
    buffer_store_dwordx4 v[20:23], v13, s[16:19], s6 offen sc0 sc1
    s_add_u32 s6, s6, 0x40000
    ds_read_b64_tr_b16 v[44:45], v12 offset:896
    ds_read_b64_tr_b16 v[46:47], v12 offset:6080
    s_waitcnt lgkmcnt(10)
    buffer_store_dwordx4 v[24:27], v13, s[16:19], s6 offen sc0 sc1
    s_add_u32 s6, s6, 0x40000
    ds_read_b64_tr_b16 v[48:49], v12 offset:1024
    ds_read_b64_tr_b16 v[50:51], v12 offset:6208
    s_waitcnt lgkmcnt(10)
    buffer_store_dwordx4 v[28:31], v13, s[16:19], s6 offen sc0 sc1
    s_add_u32 s6, s6, 0x40000
    ds_read_b64_tr_b16 v[52:53], v12 offset:1152
    ds_read_b64_tr_b16 v[54:55], v12 offset:6336
    s_waitcnt lgkmcnt(10)
    buffer_store_dwordx4 v[32:35], v13, s[16:19], s6 offen sc0 sc1
    s_add_u32 s6, s6, 0x40000
    s_waitcnt lgkmcnt(8)
    buffer_store_dwordx4 v[36:39], v13, s[16:19], s6 offen sc0 sc1
    s_add_u32 s6, s6, 0x40000
    s_waitcnt lgkmcnt(6)
    buffer_store_dwordx4 v[40:43], v13, s[16:19], s6 offen sc0 sc1
    s_add_u32 s6, s6, 0x40000
    s_waitcnt lgkmcnt(4)
    buffer_store_dwordx4 v[44:47], v13, s[16:19], s6 offen sc0 sc1
    s_add_u32 s6, s6, 0x40000
    s_waitcnt lgkmcnt(2)
    buffer_store_dwordx4 v[48:51], v13, s[16:19], s6 offen sc0 sc1
    s_add_u32 s6, s6, 0x40000
    s_waitcnt lgkmcnt(0)
    buffer_store_dwordx4 v[52:55], v13, s[16:19], s6 offen sc0 sc1
    s_add_u32 s6, s6, 0x40000
    s_nop 1
    v_add_f32_dpp v5, v5, v5 quad_perm:[1,0,3,2] row_mask:0xf bank_mask:0xf
    v_add_f32_dpp v6, v6, v6 quad_perm:[1,0,3,2] row_mask:0xf bank_mask:0xf
    s_nop 1
    v_add_f32_dpp v5, v5, v5 quad_perm:[2,3,0,1] row_mask:0xf bank_mask:0xf
    v_add_f32_dpp v6, v6, v6 quad_perm:[2,3,0,1] row_mask:0xf bank_mask:0xf
    s_nop 1
    v_add_f32_dpp v5, v5, v5 row_half_mirror row_mask:0xf bank_mask:0xf
    v_add_f32_dpp v6, v6, v6 row_half_mirror row_mask:0xf bank_mask:0xf
    v_mul_f32 v5, 0x3acccccd, v5
    v_mul_f32 v6, 0x3acccccd, v6
    v_fma_f32 v6, -v5, v5, v6
    v_max_f32 v6, 0, v6
    v_cvt_pk_bf16_f32 v5, v5, v5
    v_lshlrev_b32 v5, 16, v5
    v_cvt_pk_bf16_f32 v6, v6, v6
    v_lshlrev_b32 v6, 16, v6
    v_add_f32 v6, 0x3727c5ac, v6
    v_cvt_pk_bf16_f32 v6, v6, v6
    v_lshlrev_b32 v6, 16, v6
    v_sqrt_f32 v6, v6
    s_nop 0
    v_cvt_pk_bf16_f32 v6, v6, v6
    v_lshlrev_b32 v6, 16, v6
    v_rcp_f32 v6, v6
    s_lshr_b32 s6, s4, 4
    s_lshl_b32 s6, s6, 11
    s_and_b32 s7, s4, 15
    s_lshl_b32 s7, s7, 6
    s_add_u32 s6, s6, s7
    v_mul_f32 v5, -v5, v6
    v_mov_b32 v7, 0
    buffer_store_dword v6, v15, s[20:23], s6 offen
    s_add_u32 s6, s6, 8192
    buffer_store_dword v5, v15, s[20:23], s6 offen
    s_add_u32 s6, s6, 0x6000
    buffer_store_dword v7, v15, s[20:23], s6 offen
    s_endpgm
A_m:
    s_load_dwordx4 s[8:11], s[0:1], 88
    s_load_dwordx2 s[12:13], s[0:1], 120
    s_setprio 0
    s_and_b32 s5, s4, 3
    s_lshr_b32 s4, s4, 2
    v_lshrrev_b32 v1, 3, v0
    v_and_b32 v2, 7, v0
    v_mul_u32_u24 v3, 7680, v1
    v_lshl_add_u32 v3, v2, 4, v3
    v_lshlrev_b32 v4, 1, v1
    s_mul_i32 s6, s5, 1228800
    s_lshl_b32 s7, s4, 7
    s_add_u32 s6, s6, s7
    s_mul_i32 s7, s5, 320
    s_waitcnt lgkmcnt(0)
    s_mov_b32 s16, s8
    s_mov_b32 s17, s9
    s_mov_b32 s18, 0x500
    s_mov_b32 s19, 0x00020000
    s_mov_b32 s20, s10
    s_mov_b32 s21, s11
    s_mov_b32 s22, 0x4b0000
    s_mov_b32 s23, 0x00020000
    s_add_u32 s24, s12, 0x790000
    s_addc_u32 s25, s13, 0
    s_mov_b32 s26, 0xf000
    s_mov_b32 s27, 0x00020000
    buffer_load_ushort v8, v4, s[16:19], s7 offen offset:0
    buffer_load_ushort v9, v4, s[16:19], s7 offen offset:64
    buffer_load_ushort v10, v4, s[16:19], s7 offen offset:128
    buffer_load_ushort v11, v4, s[16:19], s7 offen offset:192
    buffer_load_ushort v12, v4, s[16:19], s7 offen offset:256
    buffer_load_dwordx4 v[16:19], v3, s[20:23], s6 offen
    s_add_u32 s6, s6, 245760
    buffer_load_dwordx4 v[20:23], v3, s[20:23], s6 offen
    s_add_u32 s6, s6, 245760
    buffer_load_dwordx4 v[24:27], v3, s[20:23], s6 offen
    s_add_u32 s6, s6, 245760
    buffer_load_dwordx4 v[28:31], v3, s[20:23], s6 offen
    s_add_u32 s6, s6, 245760
    buffer_load_dwordx4 v[32:35], v3, s[20:23], s6 offen
    s_add_u32 s6, s6, 245760
    s_mov_b32 s28, 0x3fb8aa3b
    s_mov_b32 s29, 0xffff0000
    s_waitcnt vmcnt(5)
    v_lshlrev_b32 v8, 16, v8
    v_mul_f32 v13, s28, v8
    v_exp_f32 v13, -v13
    s_nop 0
    v_add_f32 v13, 1.0, v13
    v_rcp_f32 v13, v13
    s_nop 0
    v_mul_f32 v8, v8, v13
    v_cvt_pk_bf16_f32 v8, v8, v8
    v_lshlrev_b32 v8, 16, v8
    v_lshlrev_b32 v9, 16, v9
    v_mul_f32 v13, s28, v9
    v_exp_f32 v13, -v13
    s_nop 0
    v_add_f32 v13, 1.0, v13
    v_rcp_f32 v13, v13
    s_nop 0
    v_mul_f32 v9, v9, v13
    v_cvt_pk_bf16_f32 v9, v9, v9
    v_lshlrev_b32 v9, 16, v9
    v_lshlrev_b32 v10, 16, v10
    v_mul_f32 v13, s28, v10
    v_exp_f32 v13, -v13
    s_nop 0
    v_add_f32 v13, 1.0, v13
    v_rcp_f32 v13, v13
    s_nop 0
    v_mul_f32 v10, v10, v13
    v_cvt_pk_bf16_f32 v10, v10, v10
    v_lshlrev_b32 v10, 16, v10
    v_lshlrev_b32 v11, 16, v11
    v_mul_f32 v13, s28, v11
    v_exp_f32 v13, -v13
    s_nop 0
    v_add_f32 v13, 1.0, v13
    v_rcp_f32 v13, v13
    s_nop 0
    v_mul_f32 v11, v11, v13
    v_cvt_pk_bf16_f32 v11, v11, v11
    v_lshlrev_b32 v11, 16, v11
    v_lshlrev_b32 v12, 16, v12
    v_mul_f32 v13, s28, v12
    v_exp_f32 v13, -v13
    s_nop 0
    v_add_f32 v13, 1.0, v13
    v_rcp_f32 v13, v13
    s_nop 0
    v_mul_f32 v12, v12, v13
    v_cvt_pk_bf16_f32 v12, v12, v12
    v_lshlrev_b32 v12, 16, v12
    s_waitcnt vmcnt(4)
    v_lshlrev_b32 v13, 16, v16
    v_and_b32 v14, s29, v16
    v_mul_f32 v40, v13, v8
    v_mul_f32 v41, v14, v8
    v_lshlrev_b32 v13, 16, v17
    v_and_b32 v14, s29, v17
    v_mul_f32 v42, v13, v8
    v_mul_f32 v43, v14, v8
    v_lshlrev_b32 v13, 16, v18
    v_and_b32 v14, s29, v18
    v_mul_f32 v44, v13, v8
    v_mul_f32 v45, v14, v8
    v_lshlrev_b32 v13, 16, v19
    v_and_b32 v14, s29, v19
    v_mul_f32 v46, v13, v8
    v_mul_f32 v47, v14, v8
    s_waitcnt vmcnt(3)
    v_lshlrev_b32 v13, 16, v20
    v_and_b32 v14, s29, v20
    v_fmac_f32 v40, v13, v9
    v_fmac_f32 v41, v14, v9
    v_lshlrev_b32 v13, 16, v21
    v_and_b32 v14, s29, v21
    v_fmac_f32 v42, v13, v9
    v_fmac_f32 v43, v14, v9
    v_lshlrev_b32 v13, 16, v22
    v_and_b32 v14, s29, v22
    v_fmac_f32 v44, v13, v9
    v_fmac_f32 v45, v14, v9
    v_lshlrev_b32 v13, 16, v23
    v_and_b32 v14, s29, v23
    v_fmac_f32 v46, v13, v9
    v_fmac_f32 v47, v14, v9
    s_waitcnt vmcnt(2)
    v_lshlrev_b32 v13, 16, v24
    v_and_b32 v14, s29, v24
    v_fmac_f32 v40, v13, v10
    v_fmac_f32 v41, v14, v10
    v_lshlrev_b32 v13, 16, v25
    v_and_b32 v14, s29, v25
    v_fmac_f32 v42, v13, v10
    v_fmac_f32 v43, v14, v10
    v_lshlrev_b32 v13, 16, v26
    v_and_b32 v14, s29, v26
    v_fmac_f32 v44, v13, v10
    v_fmac_f32 v45, v14, v10
    v_lshlrev_b32 v13, 16, v27
    v_and_b32 v14, s29, v27
    v_fmac_f32 v46, v13, v10
    v_fmac_f32 v47, v14, v10
    s_waitcnt vmcnt(1)
    v_lshlrev_b32 v13, 16, v28
    v_and_b32 v14, s29, v28
    v_fmac_f32 v40, v13, v11
    v_fmac_f32 v41, v14, v11
    v_lshlrev_b32 v13, 16, v29
    v_and_b32 v14, s29, v29
    v_fmac_f32 v42, v13, v11
    v_fmac_f32 v43, v14, v11
    v_lshlrev_b32 v13, 16, v30
    v_and_b32 v14, s29, v30
    v_fmac_f32 v44, v13, v11
    v_fmac_f32 v45, v14, v11
    v_lshlrev_b32 v13, 16, v31
    v_and_b32 v14, s29, v31
    v_fmac_f32 v46, v13, v11
    v_fmac_f32 v47, v14, v11
    s_waitcnt vmcnt(0)
    v_lshlrev_b32 v13, 16, v32
    v_and_b32 v14, s29, v32
    v_fmac_f32 v40, v13, v12
    v_fmac_f32 v41, v14, v12
    v_lshlrev_b32 v13, 16, v33
    v_and_b32 v14, s29, v33
    v_fmac_f32 v42, v13, v12
    v_fmac_f32 v43, v14, v12
    v_lshlrev_b32 v13, 16, v34
    v_and_b32 v14, s29, v34
    v_fmac_f32 v44, v13, v12
    v_fmac_f32 v45, v14, v12
    v_lshlrev_b32 v13, 16, v35
    v_and_b32 v14, s29, v35
    v_fmac_f32 v46, v13, v12
    v_fmac_f32 v47, v14, v12
    v_lshlrev_b32 v5, 5, v0
    ds_write_b128 v5, v[40:43]
    ds_write_b128 v5, v[44:47] offset:16
    v_and_b32 v6, 63, v0
    v_lshrrev_b32 v7, 6, v0
    v_lshlrev_b32 v6, 2, v6
    v_lshl_add_u32 v5, v7, 11, v6
    s_waitcnt lgkmcnt(0)
    ds_read_b32 v16, v5 offset:0
    ds_read_b32 v17, v5 offset:256
    ds_read_b32 v18, v5 offset:512
    ds_read_b32 v19, v5 offset:768
    ds_read_b32 v20, v5 offset:1024
    ds_read_b32 v21, v5 offset:1280
    ds_read_b32 v22, v5 offset:1536
    ds_read_b32 v23, v5 offset:1792
    s_waitcnt lgkmcnt(0)
    v_add_f32 v16, v16, v17
    v_add_f32 v16, v16, v18
    v_add_f32 v16, v16, v19
    v_add_f32 v16, v16, v20
    v_add_f32 v16, v16, v21
    v_add_f32 v16, v16, v22
    v_add_f32 v16, v16, v23
    v_lshlrev_b32 v5, 2, v0
    ds_write_b32 v5, v16 offset:8192
    s_waitcnt lgkmcnt(0)
    s_barrier
    ds_read_b32 v16, v6 offset:8192
    ds_read_b32 v17, v6 offset:8448
    ds_read_b32 v18, v6 offset:8704
    ds_read_b32 v19, v6 offset:8960
    s_mul_i32 s6, s5, 15360
    s_lshl_b32 s7, s4, 8
    s_add_u32 s6, s6, s7
    s_waitcnt lgkmcnt(0)
    v_add_f32 v16, v16, v17
    v_add_f32 v18, v18, v19
    v_add_f32 v16, v16, v18
    v_cmp_gt_u32 vcc, 64, v0
    s_and_saveexec_b64 s[30:31], vcc
    s_cbranch_execz A_end
    buffer_store_dword v16, v6, s[24:27], s6 offen
A_end:
    s_endpgm
.globl kb_kernel
.p2align 8
.type kb_kernel,@function
kb_kernel:
    s_cmp_ge_u32 s2, 254
    s_cbranch_scc1 B_end
    s_sub_u32 s4, s2, 14
    s_cmp_ge_u32 s2, 214
    s_cbranch_scc1 B_m
    s_cmp_ge_u32 s2, 160
    s_cbranch_scc1 B_uv
    s_setprio 2
    s_load_dwordx2 s[8:9], s[0:1], 48
    s_load_dwordx2 s[10:11], s[0:1], 120
    v_lshrrev_b32 v1, 6, v0
    v_and_b32 v0, 63, v0
    s_nop 0
    v_readfirstlane_b32 s3, v1
    s_lshl_b32 s4, s2, 2
    s_add_u32 s4, s4, s3
    s_lshl_b32 s5, s4, 12
    v_and_b32 v2, 15, v0
    v_lshrrev_b32 v3, 4, v0
    v_lshlrev_b32 v4, 5, v2
    v_lshl_add_u32 v4, v3, 3, v4
    v_lshlrev_b32 v6, 4, v0
    s_lshl_b32 s6, s4, 1
    v_mov_b32 v7, s6
    s_lshl_b32 s7, s3, 12
    s_add_u32 m0, s7, 51712
    s_waitcnt lgkmcnt(0)
    s_add_u32 s6, s5, 0x500000
    s_add_u32 s12, s10, s6
    s_addc_u32 s13, s11, 0
    s_mov_b32 s14, 0x1000
    s_mov_b32 s15, 0x00020000
    s_add_u32 s16, s10, s5
    s_addc_u32 s17, s11, 0
    s_mov_b32 s18, 0x1000
    s_mov_b32 s19, 0x00020000
    s_add_u32 s20, s10, 0x780000
    s_addc_u32 s21, s11, 0
    s_mov_b32 s22, 0x4000
    s_mov_b32 s23, 0x00020000
    s_mov_b32 s28, s8
    s_mov_b32 s29, s9
    s_mov_b32 s30, 0x500
    s_mov_b32 s31, 0x00020000
    buffer_load_dwordx4 v[64:67], v6, s[12:15], 0 offen offset:0
    buffer_load_dwordx4 v[68:71], v6, s[12:15], 0 offen offset:1024
    buffer_load_dwordx4 v[72:75], v6, s[12:15], 0 offen offset:2048
    buffer_load_dwordx4 v[76:79], v6, s[12:15], 0 offen offset:3072
    buffer_load_dwordx4 v6, s[20:23], s7 offen offset:0 lds
    buffer_load_dwordx4 v6, s[20:23], s7 offen offset:1024 lds
    buffer_load_dwordx4 v6, s[20:23], s7 offen offset:2048 lds
    buffer_load_dwordx4 v6, s[20:23], s7 offen offset:3072 lds
    s_mul_i32 s34, s3, 12928
    s_add_u32 m0, s34, 512
    v_lshlrev_b32 v15, 6, v0
    buffer_load_dwordx4 v6, s[16:19], 0 offen offset:0 lds
    buffer_load_dwordx4 v6, s[16:19], 0 offen offset:1024 lds
    buffer_load_dwordx4 v6, s[16:19], 0 offen offset:2048 lds
    buffer_load_dwordx4 v6, s[16:19], 0 offen offset:3072 lds
    buffer_load_ushort v7, v7, s[28:31], 0 offen
    s_lshl_b32 s6, s4, 2
    s_add_u32 s6, s6, 0x790000
    s_add_u32 s32, s10, s6
    s_addc_u32 s33, s11, 0
    s_load_dword s36, s[32:33], 0x0
    s_load_dword s37, s[32:33], 0x3c00
    s_load_dword s38, s[32:33], 0x7800
    s_load_dword s39, s[32:33], 0xb400
    s_load_dword s40, s[32:33], 0xa00
    s_load_dword s41, s[32:33], 0x4600
    s_load_dword s42, s[32:33], 0x8200
    s_load_dword s43, s[32:33], 0xbe00
    s_load_dword s44, s[32:33], 0x1400
    s_load_dword s45, s[32:33], 0x5000
    s_load_dword s46, s[32:33], 0x8c00
    s_load_dword s47, s[32:33], 0xc800
    s_load_dword s48, s[32:33], 0x2800
    s_load_dword s49, s[32:33], 0x6400
    s_load_dword s50, s[32:33], 0xa000
    s_load_dword s51, s[32:33], 0xdc00
    s_add_u32 s6, s5, 0x280000
    s_add_u32 s24, s10, s6
    s_addc_u32 s25, s11, 0
    s_mov_b32 s26, 0x588000
    s_mov_b32 s27, 0x00020000
    s_mul_i32 s7, s3, 12928
    v_mov_b32 v8, 0
    v_mov_b32 v9, 0
    v_lshl_add_u32 v10, v0, 3, s7
    ds_write_b64 v10, v[8:9]
    v_lshl_add_u32 v10, v2, 2, s7
    ds_write_b32 v10, v8 offset:8704
    ds_write_b32 v10, v8 offset:12864
    v_add_u32 v10, s7, v6
    v_add_u32 v11, s7, v4
    v_lshlrev_b32 v12, 5, v2
    v_lshl_add_u32 v12, v3, 4, v12
    v_add_u32 v12, s7, v12
    v_add_u32 v12, 32, v12
    v_and_b32 v13, 1, v2
    v_mul_u32_u24 v13, 4158, v13
    v_lshlrev_b32 v14, 4, v3
    v_sub_u32 v14, v14, v13
    v_lshlrev_b32 v13, 1, v2
    v_sub_u32 v14, v14, v13
    v_add_u32 v14, s7, v14
    v_add_u32 v104, 11868, v14
    v_add_u32 v105, 10844, v14
    v_add_u32 v106, 9820, v14
    v_add_u32 v107, 8796, v14
    s_waitcnt vmcnt(12)
    ds_write_b128 v10, v[64:67] offset:4608
    s_waitcnt vmcnt(11)
    ds_write_b128 v10, v[68:71] offset:5632
    s_waitcnt vmcnt(10)
    ds_write_b128 v10, v[72:75] offset:6656
    s_waitcnt vmcnt(9)
    ds_write_b128 v10, v[76:79] offset:7680
    ds_read_b32 v80, v10 offset:4624
    ds_read_b32 v81, v10 offset:5648
    ds_read_b32 v82, v10 offset:6672
    ds_read_b32 v83, v10 offset:7696
    v_lshl_add_u32 v15, v1, 4, v15
    s_waitcnt vmcnt(1) lgkmcnt(0)
    s_barrier
    ds_read_b128 v[16:19], v15 offset:512
    ds_read_b128 v[20:23], v15 offset:13440
    ds_read_b128 v[24:27], v15 offset:26368
    ds_read_b128 v[28:31], v15 offset:39296
    v_add_u32 v5, 51712, v6
    ds_read_b128 v[112:115], v5 offset:0
    ds_read_b128 v[116:119], v5 offset:8192
    ds_read_b128 v[120:123], v5 offset:1024
    ds_read_b128 v[124:127], v5 offset:9216
    ds_read_b128 v[128:131], v5 offset:2048
    ds_read_b128 v[132:135], v5 offset:10240
    ds_read_b128 v[136:139], v5 offset:3072
    ds_read_b128 v[140:143], v5 offset:11264
    ds_read_b128 v[144:147], v5 offset:4096
    ds_read_b128 v[148:151], v5 offset:12288
    ds_read_b128 v[152:155], v5 offset:5120
    ds_read_b128 v[156:159], v5 offset:13312
    ds_read_b128 v[160:163], v5 offset:6144
    ds_read_b128 v[164:167], v5 offset:14336
    ds_read_b128 v[168:171], v5 offset:7168
    ds_read_b128 v[172:175], v5 offset:15360
    v_alignbit_b32 v32, v65, v64, 16
    v_alignbit_b32 v33, v66, v65, 16
    v_alignbit_b32 v34, v67, v66, 16
    v_alignbit_b32 v35, v80, v67, 16
    ds_write_b128 v10, v[32:35] offset:8768
    v_alignbit_b32 v36, v69, v68, 16
    v_alignbit_b32 v37, v70, v69, 16
    v_alignbit_b32 v38, v71, v70, 16
    v_alignbit_b32 v39, v81, v71, 16
    ds_write_b128 v10, v[36:39] offset:9792
    v_alignbit_b32 v40, v73, v72, 16
    v_alignbit_b32 v41, v74, v73, 16
    v_alignbit_b32 v42, v75, v74, 16
    v_alignbit_b32 v43, v82, v75, 16
    ds_write_b128 v10, v[40:43] offset:10816
    v_alignbit_b32 v44, v77, v76, 16
    v_alignbit_b32 v45, v78, v77, 16
    v_alignbit_b32 v46, v79, v78, 16
    v_alignbit_b32 v47, v83, v79, 16
    ds_write_b128 v10, v[44:47] offset:11840
    v_mov_b32 v108, s36
    v_add_f32 v108, s37, v108
    v_add_f32 v108, s38, v108
    v_add_f32 v108, s39, v108
    v_cvt_pk_bf16_f32 v108, v108, v108
    v_lshlrev_b32 v108, 16, v108
    v_mov_b32 v109, s40
    v_add_f32 v109, s41, v109
    v_add_f32 v109, s42, v109
    v_add_f32 v109, s43, v109
    v_cvt_pk_bf16_f32 v109, v109, v109
    v_lshlrev_b32 v109, 16, v109
    v_mov_b32 v110, s44
    v_add_f32 v110, s45, v110
    v_add_f32 v110, s46, v110
    v_add_f32 v110, s47, v110
    v_cvt_pk_bf16_f32 v110, v110, v110
    v_lshlrev_b32 v110, 16, v110
    v_mov_b32 v14, s48
    v_add_f32 v14, s49, v14
    v_add_f32 v14, s50, v14
    v_add_f32 v14, s51, v14
    v_cvt_pk_bf16_f32 v14, v14, v14
    v_lshlrev_b32 v14, 16, v14
    v_add_f32 v14, 1.0, v14
    s_and_b32 s34, s4, 7
    s_mul_i32 s34, s34, 3968
    s_sub_u32 s34, 0x586000, s34
    v_cvt_pk_bf16_f32 v14, v14, v14
    v_lshlrev_b32 v14, 16, v14
    v_add_f32 v109, 1.0, v109
    v_cvt_pk_bf16_f32 v109, v109, v109
    v_lshlrev_b32 v109, 16, v109
    s_mov_b32 s35, 0xffff0000
    s_waitcnt lgkmcnt(0)
    s_barrier
    v_lshlrev_b32 v64, 16, v16
    v_and_b32 v65, s35, v16
    v_lshlrev_b32 v66, 16, v17
    v_and_b32 v67, s35, v17
    v_pk_fma_f32 v[64:65], v[64:65], v[112:113], v[116:117]
    v_pk_fma_f32 v[66:67], v[66:67], v[114:115], v[118:119]
    v_pk_fma_f32 v[64:65], v[64:65], v[108:109], v[108:109] op_sel:[0,1,0] op_sel_hi:[1,1,0]
    v_pk_fma_f32 v[66:67], v[66:67], v[108:109], v[108:109] op_sel:[0,1,0] op_sel_hi:[1,1,0]
    v_cvt_pk_bf16_f32 v88, v64, v65
    v_cvt_pk_bf16_f32 v89, v66, v67
    ds_write_b64 v11, v[88:89] offset:512
    v_lshlrev_b32 v68, 16, v18
    v_and_b32 v69, s35, v18
    v_lshlrev_b32 v70, 16, v19
    v_and_b32 v71, s35, v19
    v_pk_fma_f32 v[68:69], v[68:69], v[120:121], v[124:125]
    v_pk_fma_f32 v[70:71], v[70:71], v[122:123], v[126:127]
    v_pk_fma_f32 v[68:69], v[68:69], v[108:109], v[108:109] op_sel:[0,1,0] op_sel_hi:[1,1,0]
    v_pk_fma_f32 v[70:71], v[70:71], v[108:109], v[108:109] op_sel:[0,1,0] op_sel_hi:[1,1,0]
    v_cvt_pk_bf16_f32 v90, v68, v69
    v_cvt_pk_bf16_f32 v91, v70, v71
    ds_write_b64 v11, v[90:91] offset:1024
    v_lshlrev_b32 v64, 16, v20
    v_and_b32 v65, s35, v20
    v_lshlrev_b32 v66, 16, v21
    v_and_b32 v67, s35, v21
    v_pk_fma_f32 v[64:65], v[64:65], v[128:129], v[132:133]
    v_pk_fma_f32 v[66:67], v[66:67], v[130:131], v[134:135]
    v_pk_fma_f32 v[64:65], v[64:65], v[108:109], v[108:109] op_sel:[0,1,0] op_sel_hi:[1,1,0]
    v_pk_fma_f32 v[66:67], v[66:67], v[108:109], v[108:109] op_sel:[0,1,0] op_sel_hi:[1,1,0]
    v_cvt_pk_bf16_f32 v92, v64, v65
    v_cvt_pk_bf16_f32 v93, v66, v67
    ds_write_b64 v11, v[92:93] offset:1536
    v_lshlrev_b32 v68, 16, v22
    v_and_b32 v69, s35, v22
    v_lshlrev_b32 v70, 16, v23
    v_and_b32 v71, s35, v23
    v_pk_fma_f32 v[68:69], v[68:69], v[136:137], v[140:141]
    v_pk_fma_f32 v[70:71], v[70:71], v[138:139], v[142:143]
    v_pk_fma_f32 v[68:69], v[68:69], v[108:109], v[108:109] op_sel:[0,1,0] op_sel_hi:[1,1,0]
    v_pk_fma_f32 v[70:71], v[70:71], v[108:109], v[108:109] op_sel:[0,1,0] op_sel_hi:[1,1,0]
    v_cvt_pk_bf16_f32 v94, v68, v69
    v_cvt_pk_bf16_f32 v95, v70, v71
    ds_write_b64 v11, v[94:95] offset:2048
    v_lshlrev_b32 v64, 16, v24
    v_and_b32 v65, s35, v24
    v_lshlrev_b32 v66, 16, v25
    v_and_b32 v67, s35, v25
    v_pk_fma_f32 v[64:65], v[64:65], v[144:145], v[148:149]
    v_pk_fma_f32 v[66:67], v[66:67], v[146:147], v[150:151]
    v_pk_fma_f32 v[64:65], v[64:65], v[108:109], v[108:109] op_sel:[0,1,0] op_sel_hi:[1,1,0]
    v_pk_fma_f32 v[66:67], v[66:67], v[108:109], v[108:109] op_sel:[0,1,0] op_sel_hi:[1,1,0]
    v_cvt_pk_bf16_f32 v96, v64, v65
    v_cvt_pk_bf16_f32 v97, v66, v67
    ds_write_b64 v11, v[96:97] offset:2560
    v_lshlrev_b32 v68, 16, v26
    v_and_b32 v69, s35, v26
    v_lshlrev_b32 v70, 16, v27
    v_and_b32 v71, s35, v27
    v_pk_fma_f32 v[68:69], v[68:69], v[152:153], v[156:157]
    v_pk_fma_f32 v[70:71], v[70:71], v[154:155], v[158:159]
    v_pk_fma_f32 v[68:69], v[68:69], v[108:109], v[108:109] op_sel:[0,1,0] op_sel_hi:[1,1,0]
    v_pk_fma_f32 v[70:71], v[70:71], v[108:109], v[108:109] op_sel:[0,1,0] op_sel_hi:[1,1,0]
    v_cvt_pk_bf16_f32 v98, v68, v69
    v_cvt_pk_bf16_f32 v99, v70, v71
    ds_write_b64 v11, v[98:99] offset:3072
    v_lshlrev_b32 v64, 16, v28
    v_and_b32 v65, s35, v28
    v_lshlrev_b32 v66, 16, v29
    v_and_b32 v67, s35, v29
    v_pk_fma_f32 v[64:65], v[64:65], v[160:161], v[164:165]
    v_pk_fma_f32 v[66:67], v[66:67], v[162:163], v[166:167]
    v_pk_fma_f32 v[64:65], v[64:65], v[108:109], v[108:109] op_sel:[0,1,0] op_sel_hi:[1,1,0]
    v_pk_fma_f32 v[66:67], v[66:67], v[108:109], v[108:109] op_sel:[0,1,0] op_sel_hi:[1,1,0]
    v_cvt_pk_bf16_f32 v100, v64, v65
    v_cvt_pk_bf16_f32 v101, v66, v67
    ds_write_b64 v11, v[100:101] offset:3584
    v_lshlrev_b32 v68, 16, v30
    v_and_b32 v69, s35, v30
    v_lshlrev_b32 v70, 16, v31
    v_and_b32 v71, s35, v31
    v_pk_fma_f32 v[68:69], v[68:69], v[168:169], v[172:173]
    v_pk_fma_f32 v[70:71], v[70:71], v[170:171], v[174:175]
    v_pk_fma_f32 v[68:69], v[68:69], v[108:109], v[108:109] op_sel:[0,1,0] op_sel_hi:[1,1,0]
    v_pk_fma_f32 v[70:71], v[70:71], v[108:109], v[108:109] op_sel:[0,1,0] op_sel_hi:[1,1,0]
    v_cvt_pk_bf16_f32 v102, v68, v69
    v_cvt_pk_bf16_f32 v103, v70, v71
    ds_write_b64 v11, v[102:103] offset:4096
    s_waitcnt vmcnt(0) lgkmcnt(0)
    v_lshlrev_b32 v111, 16, v7
    ds_read2_b32 v[112:113], v104 offset0:240 offset1:241
    ds_read2_b32 v[114:115], v104 offset0:242 offset1:243
    ds_read_b128 v[144:147], v12 offset:448
    ds_read2_b32 v[116:117], v104 offset0:112 offset1:113
    ds_read2_b32 v[118:119], v104 offset0:114 offset1:115
    ds_read_b128 v[148:151], v12 offset:960
    ds_read2_b32 v[120:121], v105 offset0:240 offset1:241
    ds_read2_b32 v[122:123], v105 offset0:242 offset1:243
    ds_read_b128 v[152:155], v12 offset:1472
    ds_read2_b32 v[124:125], v105 offset0:112 offset1:113
    ds_read2_b32 v[126:127], v105 offset0:114 offset1:115
    ds_read_b128 v[156:159], v12 offset:1984
    ds_read2_b32 v[128:129], v106 offset0:240 offset1:241
    ds_read2_b32 v[130:131], v106 offset0:242 offset1:243
    ds_read_b128 v[160:163], v12 offset:2496
    ds_read2_b32 v[132:133], v106 offset0:112 offset1:113
    ds_read2_b32 v[134:135], v106 offset0:114 offset1:115
    ds_read_b128 v[164:167], v12 offset:3008
    ds_read2_b32 v[136:137], v107 offset0:240 offset1:241
    ds_read2_b32 v[138:139], v107 offset0:242 offset1:243
    ds_read_b128 v[168:171], v12 offset:3520
    ds_read2_b32 v[140:141], v107 offset0:112 offset1:113
    ds_read2_b32 v[142:143], v107 offset0:114 offset1:115
    ds_read_b128 v[172:175], v12 offset:4032
    s_waitcnt lgkmcnt(0)
    v_mfma_f32_16x16x32_bf16 v[32:35], v[112:115], v[144:147], 0
    ds_read2_b32 v[176:177], v104 offset0:224 offset1:225
    v_mfma_f32_16x16x32_bf16 v[36:39], v[112:115], v[148:151], 0
    ds_read2_b32 v[178:179], v104 offset0:226 offset1:227
    v_mfma_f32_16x16x32_bf16 v[40:43], v[112:115], v[152:155], 0
    ds_read_b128 v[208:211], v12 offset:384
    v_mfma_f32_16x16x32_bf16 v[44:47], v[112:115], v[156:159], 0
    ds_read2_b32 v[180:181], v104 offset0:96 offset1:97
    v_mfma_f32_16x16x32_bf16 v[48:51], v[112:115], v[160:163], 0
    ds_read2_b32 v[182:183], v104 offset0:98 offset1:99
    v_mfma_f32_16x16x32_bf16 v[52:55], v[112:115], v[164:167], 0
    ds_read_b128 v[212:215], v12 offset:896
    v_mfma_f32_16x16x32_bf16 v[56:59], v[112:115], v[168:171], 0
    ds_read2_b32 v[184:185], v105 offset0:224 offset1:225
    v_mfma_f32_16x16x32_bf16 v[60:63], v[112:115], v[172:175], 0
    ds_read2_b32 v[186:187], v105 offset0:226 offset1:227
    v_mfma_f32_16x16x32_bf16 v[36:39], v[116:119], v[144:147], v[36:39]
    ds_read_b128 v[216:219], v12 offset:1408
    v_mfma_f32_16x16x32_bf16 v[40:43], v[116:119], v[148:151], v[40:43]
    ds_read2_b32 v[188:189], v105 offset0:96 offset1:97
    v_mfma_f32_16x16x32_bf16 v[44:47], v[116:119], v[152:155], v[44:47]
    ds_read2_b32 v[190:191], v105 offset0:98 offset1:99
    v_mfma_f32_16x16x32_bf16 v[48:51], v[116:119], v[156:159], v[48:51]
    ds_read_b128 v[220:223], v12 offset:1920
    v_mfma_f32_16x16x32_bf16 v[52:55], v[116:119], v[160:163], v[52:55]
    ds_read2_b32 v[192:193], v106 offset0:224 offset1:225
    v_mfma_f32_16x16x32_bf16 v[56:59], v[116:119], v[164:167], v[56:59]
    ds_read2_b32 v[194:195], v106 offset0:226 offset1:227
    v_mfma_f32_16x16x32_bf16 v[60:63], v[116:119], v[168:171], v[60:63]
    ds_read_b128 v[224:227], v12 offset:2432
    v_mfma_f32_16x16x32_bf16 v[40:43], v[120:123], v[144:147], v[40:43]
    ds_read2_b32 v[196:197], v106 offset0:96 offset1:97
    v_mfma_f32_16x16x32_bf16 v[44:47], v[120:123], v[148:151], v[44:47]
    ds_read2_b32 v[198:199], v106 offset0:98 offset1:99
    v_mfma_f32_16x16x32_bf16 v[48:51], v[120:123], v[152:155], v[48:51]
    ds_read_b128 v[228:231], v12 offset:2944
    v_mfma_f32_16x16x32_bf16 v[52:55], v[120:123], v[156:159], v[52:55]
    ds_read2_b32 v[200:201], v107 offset0:224 offset1:225
    v_mfma_f32_16x16x32_bf16 v[56:59], v[120:123], v[160:163], v[56:59]
    ds_read2_b32 v[202:203], v107 offset0:226 offset1:227
    v_mfma_f32_16x16x32_bf16 v[60:63], v[120:123], v[164:167], v[60:63]
    ds_read_b128 v[232:235], v12 offset:3456
    v_mfma_f32_16x16x32_bf16 v[44:47], v[124:127], v[144:147], v[44:47]
    ds_read2_b32 v[204:205], v107 offset0:96 offset1:97
    v_mfma_f32_16x16x32_bf16 v[48:51], v[124:127], v[148:151], v[48:51]
    ds_read2_b32 v[206:207], v107 offset0:98 offset1:99
    v_mfma_f32_16x16x32_bf16 v[52:55], v[124:127], v[152:155], v[52:55]
    ds_read_b128 v[236:239], v12 offset:3968
    v_mfma_f32_16x16x32_bf16 v[56:59], v[124:127], v[156:159], v[56:59]
    v_mfma_f32_16x16x32_bf16 v[60:63], v[124:127], v[160:163], v[60:63]
    v_mfma_f32_16x16x32_bf16 v[48:51], v[128:131], v[144:147], v[48:51]
    v_mfma_f32_16x16x32_bf16 v[52:55], v[128:131], v[148:151], v[52:55]
    v_mfma_f32_16x16x32_bf16 v[56:59], v[128:131], v[152:155], v[56:59]
    v_mfma_f32_16x16x32_bf16 v[60:63], v[128:131], v[156:159], v[60:63]
    v_mfma_f32_16x16x32_bf16 v[52:55], v[132:135], v[144:147], v[52:55]
    v_mfma_f32_16x16x32_bf16 v[56:59], v[132:135], v[148:151], v[56:59]
    v_mfma_f32_16x16x32_bf16 v[60:63], v[132:135], v[152:155], v[60:63]
    v_mfma_f32_16x16x32_bf16 v[56:59], v[136:139], v[144:147], v[56:59]
    v_mfma_f32_16x16x32_bf16 v[60:63], v[136:139], v[148:151], v[60:63]
    v_mfma_f32_16x16x32_bf16 v[60:63], v[140:143], v[144:147], v[60:63]
    s_mov_b32 s36, 3
B_loop:
    s_waitcnt lgkmcnt(0)
    v_mfma_f32_16x16x32_bf16 v[32:35], v[176:179], v[208:211], v[32:35]
    ds_read2_b32 v[112:113], v104 offset0:208 offset1:209
    v_mfma_f32_16x16x32_bf16 v[36:39], v[176:179], v[212:215], v[36:39]
    ds_read2_b32 v[114:115], v104 offset0:210 offset1:211
    v_mfma_f32_16x16x32_bf16 v[40:43], v[176:179], v[216:219], v[40:43]
    ds_read_b128 v[144:147], v12 offset:320
    v_mfma_f32_16x16x32_bf16 v[44:47], v[176:179], v[220:223], v[44:47]
    ds_read2_b32 v[116:117], v104 offset0:80 offset1:81
    v_mfma_f32_16x16x32_bf16 v[48:51], v[176:179], v[224:227], v[48:51]
    ds_read2_b32 v[118:119], v104 offset0:82 offset1:83
    v_mfma_f32_16x16x32_bf16 v[52:55], v[176:179], v[228:231], v[52:55]
    ds_read_b128 v[148:151], v12 offset:832
    v_mfma_f32_16x16x32_bf16 v[56:59], v[176:179], v[232:235], v[56:59]
    ds_read2_b32 v[120:121], v105 offset0:208 offset1:209
    v_mfma_f32_16x16x32_bf16 v[60:63], v[176:179], v[236:239], v[60:63]
    ds_read2_b32 v[122:123], v105 offset0:210 offset1:211
    v_mfma_f32_16x16x32_bf16 v[36:39], v[180:183], v[208:211], v[36:39]
    ds_read_b128 v[152:155], v12 offset:1344
    v_mfma_f32_16x16x32_bf16 v[40:43], v[180:183], v[212:215], v[40:43]
    ds_read2_b32 v[124:125], v105 offset0:80 offset1:81
    v_mfma_f32_16x16x32_bf16 v[44:47], v[180:183], v[216:219], v[44:47]
    ds_read2_b32 v[126:127], v105 offset0:82 offset1:83
    v_mfma_f32_16x16x32_bf16 v[48:51], v[180:183], v[220:223], v[48:51]
    ds_read_b128 v[156:159], v12 offset:1856
    v_mfma_f32_16x16x32_bf16 v[52:55], v[180:183], v[224:227], v[52:55]
    ds_read2_b32 v[128:129], v106 offset0:208 offset1:209
    v_mfma_f32_16x16x32_bf16 v[56:59], v[180:183], v[228:231], v[56:59]
    ds_read2_b32 v[130:131], v106 offset0:210 offset1:211
    v_mfma_f32_16x16x32_bf16 v[60:63], v[180:183], v[232:235], v[60:63]
    ds_read_b128 v[160:163], v12 offset:2368
    v_mfma_f32_16x16x32_bf16 v[40:43], v[184:187], v[208:211], v[40:43]
    ds_read2_b32 v[132:133], v106 offset0:80 offset1:81
    v_mfma_f32_16x16x32_bf16 v[44:47], v[184:187], v[212:215], v[44:47]
    ds_read2_b32 v[134:135], v106 offset0:82 offset1:83
    v_mfma_f32_16x16x32_bf16 v[48:51], v[184:187], v[216:219], v[48:51]
    ds_read_b128 v[164:167], v12 offset:2880
    v_mfma_f32_16x16x32_bf16 v[52:55], v[184:187], v[220:223], v[52:55]
    ds_read2_b32 v[136:137], v107 offset0:208 offset1:209
    v_mfma_f32_16x16x32_bf16 v[56:59], v[184:187], v[224:227], v[56:59]
    ds_read2_b32 v[138:139], v107 offset0:210 offset1:211
    v_mfma_f32_16x16x32_bf16 v[60:63], v[184:187], v[228:231], v[60:63]
    ds_read_b128 v[168:171], v12 offset:3392
    v_mfma_f32_16x16x32_bf16 v[44:47], v[188:191], v[208:211], v[44:47]
    ds_read2_b32 v[140:141], v107 offset0:80 offset1:81
    v_mfma_f32_16x16x32_bf16 v[48:51], v[188:191], v[212:215], v[48:51]
    ds_read2_b32 v[142:143], v107 offset0:82 offset1:83
    v_mfma_f32_16x16x32_bf16 v[52:55], v[188:191], v[216:219], v[52:55]
    ds_read_b128 v[172:175], v12 offset:3904
    v_mfma_f32_16x16x32_bf16 v[56:59], v[188:191], v[220:223], v[56:59]
    v_mfma_f32_16x16x32_bf16 v[60:63], v[188:191], v[224:227], v[60:63]
    v_mfma_f32_16x16x32_bf16 v[48:51], v[192:195], v[208:211], v[48:51]
    v_mfma_f32_16x16x32_bf16 v[52:55], v[192:195], v[212:215], v[52:55]
    v_mfma_f32_16x16x32_bf16 v[56:59], v[192:195], v[216:219], v[56:59]
    v_mfma_f32_16x16x32_bf16 v[60:63], v[192:195], v[220:223], v[60:63]
    v_mfma_f32_16x16x32_bf16 v[52:55], v[196:199], v[208:211], v[52:55]
    v_mfma_f32_16x16x32_bf16 v[56:59], v[196:199], v[212:215], v[56:59]
    v_mfma_f32_16x16x32_bf16 v[60:63], v[196:199], v[216:219], v[60:63]
    v_mfma_f32_16x16x32_bf16 v[56:59], v[200:203], v[208:211], v[56:59]
    v_mfma_f32_16x16x32_bf16 v[60:63], v[200:203], v[212:215], v[60:63]
    v_mfma_f32_16x16x32_bf16 v[60:63], v[204:207], v[208:211], v[60:63]
    s_waitcnt lgkmcnt(0)
    v_mfma_f32_16x16x32_bf16 v[32:35], v[112:115], v[144:147], v[32:35]
    ds_read2_b32 v[176:177], v104 offset0:192 offset1:193
    v_mfma_f32_16x16x32_bf16 v[36:39], v[112:115], v[148:151], v[36:39]
    ds_read2_b32 v[178:179], v104 offset0:194 offset1:195
    v_mfma_f32_16x16x32_bf16 v[40:43], v[112:115], v[152:155], v[40:43]
    ds_read_b128 v[208:211], v12 offset:256
    v_mfma_f32_16x16x32_bf16 v[44:47], v[112:115], v[156:159], v[44:47]
    ds_read2_b32 v[180:181], v104 offset0:64 offset1:65
    v_mfma_f32_16x16x32_bf16 v[48:51], v[112:115], v[160:163], v[48:51]
    ds_read2_b32 v[182:183], v104 offset0:66 offset1:67
    v_mfma_f32_16x16x32_bf16 v[52:55], v[112:115], v[164:167], v[52:55]
    ds_read_b128 v[212:215], v12 offset:768
    v_mfma_f32_16x16x32_bf16 v[56:59], v[112:115], v[168:171], v[56:59]
    ds_read2_b32 v[184:185], v105 offset0:192 offset1:193
    v_mfma_f32_16x16x32_bf16 v[60:63], v[112:115], v[172:175], v[60:63]
    ds_read2_b32 v[186:187], v105 offset0:194 offset1:195
    v_mfma_f32_16x16x32_bf16 v[36:39], v[116:119], v[144:147], v[36:39]
    ds_read_b128 v[216:219], v12 offset:1280
    v_mfma_f32_16x16x32_bf16 v[40:43], v[116:119], v[148:151], v[40:43]
    ds_read2_b32 v[188:189], v105 offset0:64 offset1:65
    v_mfma_f32_16x16x32_bf16 v[44:47], v[116:119], v[152:155], v[44:47]
    ds_read2_b32 v[190:191], v105 offset0:66 offset1:67
    v_mfma_f32_16x16x32_bf16 v[48:51], v[116:119], v[156:159], v[48:51]
    ds_read_b128 v[220:223], v12 offset:1792
    v_mfma_f32_16x16x32_bf16 v[52:55], v[116:119], v[160:163], v[52:55]
    ds_read2_b32 v[192:193], v106 offset0:192 offset1:193
    v_mfma_f32_16x16x32_bf16 v[56:59], v[116:119], v[164:167], v[56:59]
    ds_read2_b32 v[194:195], v106 offset0:194 offset1:195
    v_mfma_f32_16x16x32_bf16 v[60:63], v[116:119], v[168:171], v[60:63]
    ds_read_b128 v[224:227], v12 offset:2304
    v_mfma_f32_16x16x32_bf16 v[40:43], v[120:123], v[144:147], v[40:43]
    ds_read2_b32 v[196:197], v106 offset0:64 offset1:65
    v_mfma_f32_16x16x32_bf16 v[44:47], v[120:123], v[148:151], v[44:47]
    ds_read2_b32 v[198:199], v106 offset0:66 offset1:67
    v_mfma_f32_16x16x32_bf16 v[48:51], v[120:123], v[152:155], v[48:51]
    ds_read_b128 v[228:231], v12 offset:2816
    v_mfma_f32_16x16x32_bf16 v[52:55], v[120:123], v[156:159], v[52:55]
    ds_read2_b32 v[200:201], v107 offset0:192 offset1:193
    v_mfma_f32_16x16x32_bf16 v[56:59], v[120:123], v[160:163], v[56:59]
    ds_read2_b32 v[202:203], v107 offset0:194 offset1:195
    v_mfma_f32_16x16x32_bf16 v[60:63], v[120:123], v[164:167], v[60:63]
    ds_read_b128 v[232:235], v12 offset:3328
    v_mfma_f32_16x16x32_bf16 v[44:47], v[124:127], v[144:147], v[44:47]
    ds_read2_b32 v[204:205], v107 offset0:64 offset1:65
    v_mfma_f32_16x16x32_bf16 v[48:51], v[124:127], v[148:151], v[48:51]
    ds_read2_b32 v[206:207], v107 offset0:66 offset1:67
    v_mfma_f32_16x16x32_bf16 v[52:55], v[124:127], v[152:155], v[52:55]
    ds_read_b128 v[236:239], v12 offset:3840
    v_mfma_f32_16x16x32_bf16 v[56:59], v[124:127], v[156:159], v[56:59]
    v_mfma_f32_16x16x32_bf16 v[60:63], v[124:127], v[160:163], v[60:63]
    v_mfma_f32_16x16x32_bf16 v[48:51], v[128:131], v[144:147], v[48:51]
    v_mfma_f32_16x16x32_bf16 v[52:55], v[128:131], v[148:151], v[52:55]
    v_mfma_f32_16x16x32_bf16 v[56:59], v[128:131], v[152:155], v[56:59]
    v_mfma_f32_16x16x32_bf16 v[60:63], v[128:131], v[156:159], v[60:63]
    v_mfma_f32_16x16x32_bf16 v[52:55], v[132:135], v[144:147], v[52:55]
    v_mfma_f32_16x16x32_bf16 v[56:59], v[132:135], v[148:151], v[56:59]
    v_mfma_f32_16x16x32_bf16 v[60:63], v[132:135], v[152:155], v[60:63]
    v_mfma_f32_16x16x32_bf16 v[56:59], v[136:139], v[144:147], v[56:59]
    v_mfma_f32_16x16x32_bf16 v[60:63], v[136:139], v[148:151], v[60:63]
    v_mfma_f32_16x16x32_bf16 v[60:63], v[140:143], v[144:147], v[60:63]
    v_subrev_u32 v104, 128, v104
    v_subrev_u32 v105, 128, v105
    v_subrev_u32 v106, 128, v106
    v_subrev_u32 v107, 128, v107
    v_subrev_u32 v12, 128, v12
    s_sub_u32 s36, s36, 1
    s_cmp_lg_u32 s36, 0
    s_cbranch_scc1 B_loop
    s_waitcnt lgkmcnt(0)
    v_mfma_f32_16x16x32_bf16 v[60:63], v[176:179], v[236:239], v[60:63]
    v_mfma_f32_16x16x32_bf16 v[56:59], v[176:179], v[232:235], v[56:59]
    v_mfma_f32_16x16x32_bf16 v[60:63], v[180:183], v[232:235], v[60:63]
    v_mfma_f32_16x16x32_bf16 v[56:59], v[180:183], v[228:231], v[56:59]
    v_mfma_f32_16x16x32_bf16 v[60:63], v[184:187], v[228:231], v[60:63]
    v_mfma_f32_16x16x32_bf16 v[56:59], v[184:187], v[224:227], v[56:59]
    v_mfma_f32_16x16x32_bf16 v[60:63], v[188:191], v[224:227], v[60:63]
    v_mfma_f32_16x16x32_bf16 v[56:59], v[188:191], v[220:223], v[56:59]
    v_mfma_f32_16x16x32_bf16 v[60:63], v[192:195], v[220:223], v[60:63]
    v_mfma_f32_16x16x32_bf16 v[56:59], v[192:195], v[216:219], v[56:59]
    v_mfma_f32_16x16x32_bf16 v[60:63], v[196:199], v[216:219], v[60:63]
    v_mfma_f32_16x16x32_bf16 v[56:59], v[196:199], v[212:215], v[56:59]
    v_mfma_f32_16x16x32_bf16 v[60:63], v[200:203], v[212:215], v[60:63]
    v_mfma_f32_16x16x32_bf16 v[56:59], v[200:203], v[208:211], v[56:59]
    v_mfma_f32_16x16x32_bf16 v[60:63], v[204:207], v[208:211], v[60:63]
    v_mfma_f32_16x16x32_bf16 v[52:55], v[176:179], v[228:231], v[52:55]
    v_mfma_f32_16x16x32_bf16 v[48:51], v[176:179], v[224:227], v[48:51]
    s_nop 7
    v_lshlrev_b32 v64, 16, v100
    v_lshlrev_b32 v68, 16, v28
    v_and_b32 v65, s35, v100
    v_and_b32 v69, s35, v28
    v_mfma_f32_16x16x32_bf16 v[52:55], v[180:183], v[224:227], v[52:55]
    v_lshlrev_b32 v66, 16, v101
    v_lshlrev_b32 v70, 16, v29
    v_and_b32 v67, s35, v101
    v_and_b32 v71, s35, v29
    v_mfma_f32_16x16x32_bf16 v[48:51], v[180:183], v[220:223], v[48:51]
    v_pk_fma_f32 v[64:65], v[64:65], v[110:111], v[56:57] op_sel:[0,1,0] op_sel_hi:[1,1,1]
    v_pk_fma_f32 v[66:67], v[66:67], v[110:111], v[58:59] op_sel:[0,1,0] op_sel_hi:[1,1,1]
    v_pk_fma_f32 v[64:65], v[64:65], v[110:111], v[68:69] op_sel_hi:[1,0,1]
    v_pk_fma_f32 v[66:67], v[66:67], v[110:111], v[70:71] op_sel_hi:[1,0,1]
    v_mfma_f32_16x16x32_bf16 v[52:55], v[184:187], v[220:223], v[52:55]
    v_cvt_pk_bf16_f32 v28, v64, v65
    v_cvt_pk_bf16_f32 v29, v66, v67
    v_pk_mul_f32 v[64:65], v[64:65], v[14:15] op_sel_hi:[1,0]
    v_pk_mul_f32 v[66:67], v[66:67], v[14:15] op_sel_hi:[1,0]
    v_mfma_f32_16x16x32_bf16 v[48:51], v[184:187], v[216:219], v[48:51]
    v_cvt_pk_bf16_f32 v100, v64, v65
    v_cvt_pk_bf16_f32 v101, v66, v67
    v_lshlrev_b32 v72, 16, v102
    v_lshlrev_b32 v76, 16, v30
    v_mfma_f32_16x16x32_bf16 v[52:55], v[188:191], v[216:219], v[52:55]
    v_and_b32 v73, s35, v102
    v_and_b32 v77, s35, v30
    v_lshlrev_b32 v74, 16, v103
    v_lshlrev_b32 v78, 16, v31
    v_mfma_f32_16x16x32_bf16 v[48:51], v[188:191], v[212:215], v[48:51]
    v_and_b32 v75, s35, v103
    v_and_b32 v79, s35, v31
    v_pk_fma_f32 v[72:73], v[72:73], v[110:111], v[60:61] op_sel:[0,1,0] op_sel_hi:[1,1,1]
    v_pk_fma_f32 v[74:75], v[74:75], v[110:111], v[62:63] op_sel:[0,1,0] op_sel_hi:[1,1,1]
    v_mfma_f32_16x16x32_bf16 v[52:55], v[192:195], v[212:215], v[52:55]
    v_pk_fma_f32 v[72:73], v[72:73], v[110:111], v[76:77] op_sel_hi:[1,0,1]
    v_pk_fma_f32 v[74:75], v[74:75], v[110:111], v[78:79] op_sel_hi:[1,0,1]
    v_cvt_pk_bf16_f32 v30, v72, v73
    v_cvt_pk_bf16_f32 v31, v74, v75
    v_mfma_f32_16x16x32_bf16 v[48:51], v[192:195], v[208:211], v[48:51]
    v_pk_mul_f32 v[72:73], v[72:73], v[14:15] op_sel_hi:[1,0]
    v_pk_mul_f32 v[74:75], v[74:75], v[14:15] op_sel_hi:[1,0]
    v_cvt_pk_bf16_f32 v102, v72, v73
    v_cvt_pk_bf16_f32 v103, v74, v75
    v_mfma_f32_16x16x32_bf16 v[52:55], v[196:199], v[208:211], v[52:55]
    v_and_b32 v5, 0x70, v6
    v_and_b32 v4, 0x380, v6
    v_lshl_add_u32 v5, v4, 3, v5
    buffer_store_dwordx4 v[100:103], v5, s[24:27], s34 offen sc0 sc1
    s_sub_u32 s34, s34, 8192
    buffer_store_dwordx4 v[28:31], v6, s[24:27], 0 offen offset:3072 sc0 sc1
    v_mfma_f32_16x16x32_bf16 v[44:47], v[176:179], v[220:223], v[44:47]
    v_mfma_f32_16x16x32_bf16 v[40:43], v[176:179], v[216:219], v[40:43]
    s_nop 7
    v_lshlrev_b32 v64, 16, v96
    v_lshlrev_b32 v68, 16, v24
    v_and_b32 v65, s35, v96
    v_and_b32 v69, s35, v24
    v_mfma_f32_16x16x32_bf16 v[44:47], v[180:183], v[216:219], v[44:47]
    v_lshlrev_b32 v66, 16, v97
    v_lshlrev_b32 v70, 16, v25
    v_and_b32 v67, s35, v97
    v_and_b32 v71, s35, v25
    v_mfma_f32_16x16x32_bf16 v[40:43], v[180:183], v[212:215], v[40:43]
    v_pk_fma_f32 v[64:65], v[64:65], v[110:111], v[48:49] op_sel:[0,1,0] op_sel_hi:[1,1,1]
    v_pk_fma_f32 v[66:67], v[66:67], v[110:111], v[50:51] op_sel:[0,1,0] op_sel_hi:[1,1,1]
    v_pk_fma_f32 v[64:65], v[64:65], v[110:111], v[68:69] op_sel_hi:[1,0,1]
    v_pk_fma_f32 v[66:67], v[66:67], v[110:111], v[70:71] op_sel_hi:[1,0,1]
    v_mfma_f32_16x16x32_bf16 v[44:47], v[184:187], v[212:215], v[44:47]
    v_cvt_pk_bf16_f32 v24, v64, v65
    v_cvt_pk_bf16_f32 v25, v66, v67
    v_pk_mul_f32 v[64:65], v[64:65], v[14:15] op_sel_hi:[1,0]
    v_pk_mul_f32 v[66:67], v[66:67], v[14:15] op_sel_hi:[1,0]
    v_mfma_f32_16x16x32_bf16 v[40:43], v[184:187], v[208:211], v[40:43]
    v_cvt_pk_bf16_f32 v96, v64, v65
    v_cvt_pk_bf16_f32 v97, v66, v67
    v_lshlrev_b32 v72, 16, v98
    v_lshlrev_b32 v76, 16, v26
    v_mfma_f32_16x16x32_bf16 v[44:47], v[188:191], v[208:211], v[44:47]
    v_and_b32 v73, s35, v98
    v_and_b32 v77, s35, v26
    v_lshlrev_b32 v74, 16, v99
    v_lshlrev_b32 v78, 16, v27
    v_and_b32 v75, s35, v99
    v_and_b32 v79, s35, v27
    v_pk_fma_f32 v[72:73], v[72:73], v[110:111], v[52:53] op_sel:[0,1,0] op_sel_hi:[1,1,1]
    v_pk_fma_f32 v[74:75], v[74:75], v[110:111], v[54:55] op_sel:[0,1,0] op_sel_hi:[1,1,1]
    v_pk_fma_f32 v[72:73], v[72:73], v[110:111], v[76:77] op_sel_hi:[1,0,1]
    v_pk_fma_f32 v[74:75], v[74:75], v[110:111], v[78:79] op_sel_hi:[1,0,1]
    v_cvt_pk_bf16_f32 v26, v72, v73
    v_cvt_pk_bf16_f32 v27, v74, v75
    v_pk_mul_f32 v[72:73], v[72:73], v[14:15] op_sel_hi:[1,0]
    v_pk_mul_f32 v[74:75], v[74:75], v[14:15] op_sel_hi:[1,0]
    v_cvt_pk_bf16_f32 v98, v72, v73
    v_cvt_pk_bf16_f32 v99, v74, v75
    buffer_store_dwordx4 v[96:99], v5, s[24:27], s34 offen sc0 sc1
    s_sub_u32 s34, s34, 8192
    buffer_store_dwordx4 v[24:27], v6, s[24:27], 0 offen offset:2048 sc0 sc1
    v_mfma_f32_16x16x32_bf16 v[36:39], v[176:179], v[212:215], v[36:39]
    v_mfma_f32_16x16x32_bf16 v[32:35], v[176:179], v[208:211], v[32:35]
    s_nop 7
    v_lshlrev_b32 v64, 16, v92
    v_lshlrev_b32 v68, 16, v20
    v_and_b32 v65, s35, v92
    v_and_b32 v69, s35, v20
    v_mfma_f32_16x16x32_bf16 v[36:39], v[180:183], v[208:211], v[36:39]
    v_lshlrev_b32 v66, 16, v93
    v_lshlrev_b32 v70, 16, v21
    v_and_b32 v67, s35, v93
    v_and_b32 v71, s35, v21
    v_pk_fma_f32 v[64:65], v[64:65], v[110:111], v[40:41] op_sel:[0,1,0] op_sel_hi:[1,1,1]
    v_pk_fma_f32 v[66:67], v[66:67], v[110:111], v[42:43] op_sel:[0,1,0] op_sel_hi:[1,1,1]
    v_pk_fma_f32 v[64:65], v[64:65], v[110:111], v[68:69] op_sel_hi:[1,0,1]
    v_pk_fma_f32 v[66:67], v[66:67], v[110:111], v[70:71] op_sel_hi:[1,0,1]
    v_cvt_pk_bf16_f32 v20, v64, v65
    v_cvt_pk_bf16_f32 v21, v66, v67
    v_pk_mul_f32 v[64:65], v[64:65], v[14:15] op_sel_hi:[1,0]
    v_pk_mul_f32 v[66:67], v[66:67], v[14:15] op_sel_hi:[1,0]
    v_cvt_pk_bf16_f32 v92, v64, v65
    v_cvt_pk_bf16_f32 v93, v66, v67
    v_lshlrev_b32 v72, 16, v94
    v_lshlrev_b32 v76, 16, v22
    v_and_b32 v73, s35, v94
    v_and_b32 v77, s35, v22
    v_lshlrev_b32 v74, 16, v95
    v_lshlrev_b32 v78, 16, v23
    v_and_b32 v75, s35, v95
    v_and_b32 v79, s35, v23
    v_pk_fma_f32 v[72:73], v[72:73], v[110:111], v[44:45] op_sel:[0,1,0] op_sel_hi:[1,1,1]
    v_pk_fma_f32 v[74:75], v[74:75], v[110:111], v[46:47] op_sel:[0,1,0] op_sel_hi:[1,1,1]
    v_pk_fma_f32 v[72:73], v[72:73], v[110:111], v[76:77] op_sel_hi:[1,0,1]
    v_pk_fma_f32 v[74:75], v[74:75], v[110:111], v[78:79] op_sel_hi:[1,0,1]
    v_cvt_pk_bf16_f32 v22, v72, v73
    v_cvt_pk_bf16_f32 v23, v74, v75
    v_pk_mul_f32 v[72:73], v[72:73], v[14:15] op_sel_hi:[1,0]
    v_pk_mul_f32 v[74:75], v[74:75], v[14:15] op_sel_hi:[1,0]
    v_cvt_pk_bf16_f32 v94, v72, v73
    v_cvt_pk_bf16_f32 v95, v74, v75
    buffer_store_dwordx4 v[92:95], v5, s[24:27], s34 offen sc0 sc1
    s_sub_u32 s34, s34, 8192
    buffer_store_dwordx4 v[20:23], v6, s[24:27], 0 offen offset:1024 sc0 sc1
    s_nop 7
    v_lshlrev_b32 v64, 16, v88
    v_lshlrev_b32 v68, 16, v16
    v_and_b32 v65, s35, v88
    v_and_b32 v69, s35, v16
    v_lshlrev_b32 v66, 16, v89
    v_lshlrev_b32 v70, 16, v17
    v_and_b32 v67, s35, v89
    v_and_b32 v71, s35, v17
    v_pk_fma_f32 v[64:65], v[64:65], v[110:111], v[32:33] op_sel:[0,1,0] op_sel_hi:[1,1,1]
    v_pk_fma_f32 v[66:67], v[66:67], v[110:111], v[34:35] op_sel:[0,1,0] op_sel_hi:[1,1,1]
    v_pk_fma_f32 v[64:65], v[64:65], v[110:111], v[68:69] op_sel_hi:[1,0,1]
    v_pk_fma_f32 v[66:67], v[66:67], v[110:111], v[70:71] op_sel_hi:[1,0,1]
    v_cvt_pk_bf16_f32 v16, v64, v65
    v_cvt_pk_bf16_f32 v17, v66, v67
    v_pk_mul_f32 v[64:65], v[64:65], v[14:15] op_sel_hi:[1,0]
    v_pk_mul_f32 v[66:67], v[66:67], v[14:15] op_sel_hi:[1,0]
    v_cvt_pk_bf16_f32 v88, v64, v65
    v_cvt_pk_bf16_f32 v89, v66, v67
    v_lshlrev_b32 v72, 16, v90
    v_lshlrev_b32 v76, 16, v18
    v_and_b32 v73, s35, v90
    v_and_b32 v77, s35, v18
    v_lshlrev_b32 v74, 16, v91
    v_lshlrev_b32 v78, 16, v19
    v_and_b32 v75, s35, v91
    v_and_b32 v79, s35, v19
    v_pk_fma_f32 v[72:73], v[72:73], v[110:111], v[36:37] op_sel:[0,1,0] op_sel_hi:[1,1,1]
    v_pk_fma_f32 v[74:75], v[74:75], v[110:111], v[38:39] op_sel:[0,1,0] op_sel_hi:[1,1,1]
    v_pk_fma_f32 v[72:73], v[72:73], v[110:111], v[76:77] op_sel_hi:[1,0,1]
    v_pk_fma_f32 v[74:75], v[74:75], v[110:111], v[78:79] op_sel_hi:[1,0,1]
    v_cvt_pk_bf16_f32 v18, v72, v73
    v_cvt_pk_bf16_f32 v19, v74, v75
    v_pk_mul_f32 v[72:73], v[72:73], v[14:15] op_sel_hi:[1,0]
    v_pk_mul_f32 v[74:75], v[74:75], v[14:15] op_sel_hi:[1,0]
    v_cvt_pk_bf16_f32 v90, v72, v73
    v_cvt_pk_bf16_f32 v91, v74, v75
    buffer_store_dwordx4 v[88:91], v5, s[24:27], s34 offen sc0 sc1
    s_sub_u32 s34, s34, 8192
    buffer_store_dwordx4 v[16:19], v6, s[24:27], 0 offen offset:0 sc0 sc1
    s_endpgm
B_uv:
    s_sub_u32 s4, s2, 160
    s_and_b32 s6, s4, 1
    s_lshr_b32 s4, s4, 1
    s_load_dwordx4 s[8:11], s[0:1], 64
    s_load_dwordx2 s[12:13], s[0:1], 120
    v_lshrrev_b32 v7, 6, v0
    v_lshrrev_b32 v1, 3, v0
    v_and_b32 v2, 7, v0
    v_readfirstlane_b32 s3, v7
    v_mul_u32_u24 v3, 3456, v1
    v_lshl_add_u32 v3, v2, 4, v3
    s_lshl_b32 s7, s4, 7
    s_movk_i32 s15, 7680
    v_min_u32 v5, 159, v0
    v_lshlrev_b32 v5, 4, v5
    s_waitcnt lgkmcnt(0)
    s_cmp_eq_u32 s6, 0
    s_cselect_b32 s8, s8, s10
    s_cselect_b32 s9, s9, s11
    s_mov_b32 s16, s8
    s_mov_b32 s17, s9
    s_mov_b32 s18, 0x21c000
    s_mov_b32 s19, 0x00020000
    s_add_u32 s20, s12, 0x790000
    s_addc_u32 s21, s13, 0
    s_mov_b32 s22, 0xf000
    s_mov_b32 s23, 0x00020000
    s_add_u32 s24, s12, 0x7a0000
    s_addc_u32 s25, s13, 0
    s_mov_b32 s26, 0xd800
    s_mov_b32 s27, 0x00020000
    buffer_load_dwordx4 v[160:163], v5, s[20:23], s15 offen
    buffer_load_dwordx4 v[176:179], v5, s[20:23], s15 offen offset:2560
    s_add_u32 s15, s15, 15360
    buffer_load_dwordx4 v[164:167], v5, s[20:23], s15 offen
    buffer_load_dwordx4 v[180:183], v5, s[20:23], s15 offen offset:2560
    s_add_u32 s15, s15, 15360
    buffer_load_dwordx4 v[168:171], v5, s[20:23], s15 offen
    buffer_load_dwordx4 v[184:187], v5, s[20:23], s15 offen offset:2560
    s_add_u32 s15, s15, 15360
    buffer_load_dwordx4 v[172:175], v5, s[20:23], s15 offen
    buffer_load_dwordx4 v[188:191], v5, s[20:23], s15 offen offset:2560
    s_add_u32 s15, s15, 15360
    buffer_load_dwordx4 v[32:35], v3, s[16:19], s7 offen
    s_add_u32 s7, s7, 110592
    buffer_load_dwordx4 v[36:39], v3, s[16:19], s7 offen
    s_add_u32 s7, s7, 110592
    buffer_load_dwordx4 v[40:43], v3, s[16:19], s7 offen
    s_add_u32 s7, s7, 110592
    buffer_load_dwordx4 v[44:47], v3, s[16:19], s7 offen
    s_add_u32 s7, s7, 110592
    buffer_load_dwordx4 v[48:51], v3, s[16:19], s7 offen
    s_add_u32 s7, s7, 110592
    buffer_load_dwordx4 v[52:55], v3, s[16:19], s7 offen
    s_add_u32 s7, s7, 110592
    buffer_load_dwordx4 v[56:59], v3, s[16:19], s7 offen
    s_add_u32 s7, s7, 110592
    buffer_load_dwordx4 v[60:63], v3, s[16:19], s7 offen
    s_add_u32 s7, s7, 110592
    buffer_load_dwordx4 v[64:67], v3, s[16:19], s7 offen
    s_add_u32 s7, s7, 110592
    buffer_load_dwordx4 v[68:71], v3, s[16:19], s7 offen
    s_add_u32 s7, s7, 110592
    buffer_load_dwordx4 v[72:75], v3, s[16:19], s7 offen
    s_add_u32 s7, s7, 110592
    buffer_load_dwordx4 v[76:79], v3, s[16:19], s7 offen
    s_add_u32 s7, s7, 110592
    buffer_load_dwordx4 v[80:83], v3, s[16:19], s7 offen
    s_add_u32 s7, s7, 110592
    buffer_load_dwordx4 v[84:87], v3, s[16:19], s7 offen
    s_add_u32 s7, s7, 110592
    buffer_load_dwordx4 v[88:91], v3, s[16:19], s7 offen
    s_add_u32 s7, s7, 110592
    buffer_load_dwordx4 v[92:95], v3, s[16:19], s7 offen
    s_add_u32 s7, s7, 110592
    buffer_load_dwordx4 v[96:99], v3, s[16:19], s7 offen
    s_add_u32 s7, s7, 110592
    buffer_load_dwordx4 v[100:103], v3, s[16:19], s7 offen
    s_add_u32 s7, s7, 110592
    buffer_load_dwordx4 v[104:107], v3, s[16:19], s7 offen
    s_add_u32 s7, s7, 110592
    buffer_load_dwordx4 v[108:111], v3, s[16:19], s7 offen
    s_add_u32 s7, s7, 110592
    s_waitcnt vmcnt(20)
    v_pk_add_f32 v[160:161], v[160:161], v[164:165]
    v_pk_add_f32 v[160:161], v[160:161], v[168:169]
    v_pk_add_f32 v[160:161], v[160:161], v[172:173]
    v_cvt_pk_bf16_f32 v160, v160, v160
    v_lshlrev_b32 v160, 16, v160
    v_cvt_pk_bf16_f32 v161, v161, v161
    v_lshlrev_b32 v161, 16, v161
    v_pk_add_f32 v[162:163], v[162:163], v[166:167]
    v_pk_add_f32 v[162:163], v[162:163], v[170:171]
    v_pk_add_f32 v[162:163], v[162:163], v[174:175]
    v_cvt_pk_bf16_f32 v162, v162, v162
    v_lshlrev_b32 v162, 16, v162
    v_cvt_pk_bf16_f32 v163, v163, v163
    v_lshlrev_b32 v163, 16, v163
    v_pk_add_f32 v[176:177], v[176:177], v[180:181]
    v_pk_add_f32 v[176:177], v[176:177], v[184:185]
    v_pk_add_f32 v[176:177], v[176:177], v[188:189]
    v_cvt_pk_bf16_f32 v176, v176, v176
    v_lshlrev_b32 v176, 16, v176
    v_cvt_pk_bf16_f32 v177, v177, v177
    v_lshlrev_b32 v177, 16, v177
    v_pk_add_f32 v[178:179], v[178:179], v[182:183]
    v_pk_add_f32 v[178:179], v[178:179], v[186:187]
    v_pk_add_f32 v[178:179], v[178:179], v[190:191]
    v_cvt_pk_bf16_f32 v178, v178, v178
    v_lshlrev_b32 v178, 16, v178
    v_cvt_pk_bf16_f32 v179, v179, v179
    v_lshlrev_b32 v179, 16, v179
    v_add_f32 v176, 1.0, v176
    v_cvt_pk_bf16_f32 v176, v176, v176
    v_lshlrev_b32 v176, 16, v176
    v_add_f32 v177, 1.0, v177
    v_cvt_pk_bf16_f32 v177, v177, v177
    v_lshlrev_b32 v177, 16, v177
    v_add_f32 v178, 1.0, v178
    v_cvt_pk_bf16_f32 v178, v178, v178
    v_lshlrev_b32 v178, 16, v178
    v_add_f32 v179, 1.0, v179
    v_cvt_pk_bf16_f32 v179, v179, v179
    v_lshlrev_b32 v179, 16, v179
    ds_write_b128 v5, v[160:163] offset:24576
    ds_write_b128 v5, v[176:179] offset:27136
    v_lshlrev_b32 v4, 2, v1
    s_mov_b32 s29, 0xffff0000
    s_waitcnt lgkmcnt(0)
    s_barrier
    ds_read_b32 v112, v4 offset:27136
    ds_read_b32 v113, v4 offset:24576
    ds_read_b32 v114, v4 offset:27264
    ds_read_b32 v115, v4 offset:24704
    ds_read_b32 v116, v4 offset:27392
    ds_read_b32 v117, v4 offset:24832
    ds_read_b32 v118, v4 offset:27520
    ds_read_b32 v119, v4 offset:24960
    ds_read_b32 v120, v4 offset:27648
    ds_read_b32 v121, v4 offset:25088
    ds_read_b32 v122, v4 offset:27776
    ds_read_b32 v123, v4 offset:25216
    ds_read_b32 v124, v4 offset:27904
    ds_read_b32 v125, v4 offset:25344
    s_waitcnt lgkmcnt(0)
    ds_read_b32 v126, v4 offset:28032
    ds_read_b32 v127, v4 offset:25472
    ds_read_b32 v128, v4 offset:28160
    ds_read_b32 v129, v4 offset:25600
    ds_read_b32 v130, v4 offset:28288
    ds_read_b32 v131, v4 offset:25728
    ds_read_b32 v132, v4 offset:28416
    ds_read_b32 v133, v4 offset:25856
    ds_read_b32 v134, v4 offset:28544
    ds_read_b32 v135, v4 offset:25984
    ds_read_b32 v136, v4 offset:28672
    ds_read_b32 v137, v4 offset:26112
    ds_read_b32 v138, v4 offset:28800
    ds_read_b32 v139, v4 offset:26240
    s_waitcnt lgkmcnt(0)
    ds_read_b32 v140, v4 offset:28928
    ds_read_b32 v141, v4 offset:26368
    ds_read_b32 v142, v4 offset:29056
    ds_read_b32 v143, v4 offset:26496
    ds_read_b32 v144, v4 offset:29184
    ds_read_b32 v145, v4 offset:26624
    ds_read_b32 v146, v4 offset:29312
    ds_read_b32 v147, v4 offset:26752
    ds_read_b32 v148, v4 offset:29440
    ds_read_b32 v149, v4 offset:26880
    ds_read_b32 v150, v4 offset:29568
    ds_read_b32 v151, v4 offset:27008
    v_mov_b32 v8, 0
    v_mov_b32 v9, 0
    v_mov_b32 v10, 0
    v_mov_b32 v11, 0
    v_mov_b32 v12, 0
    v_mov_b32 v13, 0
    v_mov_b32 v14, 0
    v_mov_b32 v15, 0
    v_mov_b32 v16, 0
    v_mov_b32 v17, 0
    v_mov_b32 v18, 0
    v_mov_b32 v19, 0
    v_mov_b32 v20, 0
    v_mov_b32 v21, 0
    v_mov_b32 v22, 0
    v_mov_b32 v23, 0
    s_waitcnt lgkmcnt(0)
    s_waitcnt vmcnt(19)
    v_lshlrev_b32 v24, 16, v32
    v_and_b32 v25, s29, v32
    v_lshlrev_b32 v26, 16, v33
    v_and_b32 v27, s29, v33
    v_lshlrev_b32 v28, 16, v34
    v_and_b32 v29, s29, v34
    v_lshlrev_b32 v30, 16, v35
    v_and_b32 v31, s29, v35
    v_pk_fma_f32 v[8:9], v[24:25], v[112:113], v[8:9] op_sel_hi:[1,0,1]
    v_pk_fma_f32 v[16:17], v[24:25], v[112:113], v[16:17] op_sel:[0,1,0] op_sel_hi:[1,1,1]
    v_pk_fma_f32 v[10:11], v[26:27], v[112:113], v[10:11] op_sel_hi:[1,0,1]
    v_pk_fma_f32 v[18:19], v[26:27], v[112:113], v[18:19] op_sel:[0,1,0] op_sel_hi:[1,1,1]
    v_pk_fma_f32 v[12:13], v[28:29], v[112:113], v[12:13] op_sel_hi:[1,0,1]
    v_pk_fma_f32 v[20:21], v[28:29], v[112:113], v[20:21] op_sel:[0,1,0] op_sel_hi:[1,1,1]
    v_pk_fma_f32 v[14:15], v[30:31], v[112:113], v[14:15] op_sel_hi:[1,0,1]
    v_pk_fma_f32 v[22:23], v[30:31], v[112:113], v[22:23] op_sel:[0,1,0] op_sel_hi:[1,1,1]
    s_waitcnt vmcnt(18)
    v_lshlrev_b32 v24, 16, v36
    v_and_b32 v25, s29, v36
    v_lshlrev_b32 v26, 16, v37
    v_and_b32 v27, s29, v37
    v_lshlrev_b32 v28, 16, v38
    v_and_b32 v29, s29, v38
    v_lshlrev_b32 v30, 16, v39
    v_and_b32 v31, s29, v39
    v_pk_fma_f32 v[8:9], v[24:25], v[114:115], v[8:9] op_sel_hi:[1,0,1]
    v_pk_fma_f32 v[16:17], v[24:25], v[114:115], v[16:17] op_sel:[0,1,0] op_sel_hi:[1,1,1]
    v_pk_fma_f32 v[10:11], v[26:27], v[114:115], v[10:11] op_sel_hi:[1,0,1]
    v_pk_fma_f32 v[18:19], v[26:27], v[114:115], v[18:19] op_sel:[0,1,0] op_sel_hi:[1,1,1]
    v_pk_fma_f32 v[12:13], v[28:29], v[114:115], v[12:13] op_sel_hi:[1,0,1]
    v_pk_fma_f32 v[20:21], v[28:29], v[114:115], v[20:21] op_sel:[0,1,0] op_sel_hi:[1,1,1]
    v_pk_fma_f32 v[14:15], v[30:31], v[114:115], v[14:15] op_sel_hi:[1,0,1]
    v_pk_fma_f32 v[22:23], v[30:31], v[114:115], v[22:23] op_sel:[0,1,0] op_sel_hi:[1,1,1]
    s_waitcnt vmcnt(17)
    v_lshlrev_b32 v24, 16, v40
    v_and_b32 v25, s29, v40
    v_lshlrev_b32 v26, 16, v41
    v_and_b32 v27, s29, v41
    v_lshlrev_b32 v28, 16, v42
    v_and_b32 v29, s29, v42
    v_lshlrev_b32 v30, 16, v43
    v_and_b32 v31, s29, v43
    v_pk_fma_f32 v[8:9], v[24:25], v[116:117], v[8:9] op_sel_hi:[1,0,1]
    v_pk_fma_f32 v[16:17], v[24:25], v[116:117], v[16:17] op_sel:[0,1,0] op_sel_hi:[1,1,1]
    v_pk_fma_f32 v[10:11], v[26:27], v[116:117], v[10:11] op_sel_hi:[1,0,1]
    v_pk_fma_f32 v[18:19], v[26:27], v[116:117], v[18:19] op_sel:[0,1,0] op_sel_hi:[1,1,1]
    v_pk_fma_f32 v[12:13], v[28:29], v[116:117], v[12:13] op_sel_hi:[1,0,1]
    v_pk_fma_f32 v[20:21], v[28:29], v[116:117], v[20:21] op_sel:[0,1,0] op_sel_hi:[1,1,1]
    v_pk_fma_f32 v[14:15], v[30:31], v[116:117], v[14:15] op_sel_hi:[1,0,1]
    v_pk_fma_f32 v[22:23], v[30:31], v[116:117], v[22:23] op_sel:[0,1,0] op_sel_hi:[1,1,1]
    s_waitcnt vmcnt(16)
    v_lshlrev_b32 v24, 16, v44
    v_and_b32 v25, s29, v44
    v_lshlrev_b32 v26, 16, v45
    v_and_b32 v27, s29, v45
    v_lshlrev_b32 v28, 16, v46
    v_and_b32 v29, s29, v46
    v_lshlrev_b32 v30, 16, v47
    v_and_b32 v31, s29, v47
    v_pk_fma_f32 v[8:9], v[24:25], v[118:119], v[8:9] op_sel_hi:[1,0,1]
    v_pk_fma_f32 v[16:17], v[24:25], v[118:119], v[16:17] op_sel:[0,1,0] op_sel_hi:[1,1,1]
    v_pk_fma_f32 v[10:11], v[26:27], v[118:119], v[10:11] op_sel_hi:[1,0,1]
    v_pk_fma_f32 v[18:19], v[26:27], v[118:119], v[18:19] op_sel:[0,1,0] op_sel_hi:[1,1,1]
    v_pk_fma_f32 v[12:13], v[28:29], v[118:119], v[12:13] op_sel_hi:[1,0,1]
    v_pk_fma_f32 v[20:21], v[28:29], v[118:119], v[20:21] op_sel:[0,1,0] op_sel_hi:[1,1,1]
    v_pk_fma_f32 v[14:15], v[30:31], v[118:119], v[14:15] op_sel_hi:[1,0,1]
    v_pk_fma_f32 v[22:23], v[30:31], v[118:119], v[22:23] op_sel:[0,1,0] op_sel_hi:[1,1,1]
    s_waitcnt vmcnt(15)
    v_lshlrev_b32 v24, 16, v48
    v_and_b32 v25, s29, v48
    v_lshlrev_b32 v26, 16, v49
    v_and_b32 v27, s29, v49
    v_lshlrev_b32 v28, 16, v50
    v_and_b32 v29, s29, v50
    v_lshlrev_b32 v30, 16, v51
    v_and_b32 v31, s29, v51
    v_pk_fma_f32 v[8:9], v[24:25], v[120:121], v[8:9] op_sel_hi:[1,0,1]
    v_pk_fma_f32 v[16:17], v[24:25], v[120:121], v[16:17] op_sel:[0,1,0] op_sel_hi:[1,1,1]
    v_pk_fma_f32 v[10:11], v[26:27], v[120:121], v[10:11] op_sel_hi:[1,0,1]
    v_pk_fma_f32 v[18:19], v[26:27], v[120:121], v[18:19] op_sel:[0,1,0] op_sel_hi:[1,1,1]
    v_pk_fma_f32 v[12:13], v[28:29], v[120:121], v[12:13] op_sel_hi:[1,0,1]
    v_pk_fma_f32 v[20:21], v[28:29], v[120:121], v[20:21] op_sel:[0,1,0] op_sel_hi:[1,1,1]
    v_pk_fma_f32 v[14:15], v[30:31], v[120:121], v[14:15] op_sel_hi:[1,0,1]
    v_pk_fma_f32 v[22:23], v[30:31], v[120:121], v[22:23] op_sel:[0,1,0] op_sel_hi:[1,1,1]
    s_waitcnt vmcnt(14)
    v_lshlrev_b32 v24, 16, v52
    v_and_b32 v25, s29, v52
    v_lshlrev_b32 v26, 16, v53
    v_and_b32 v27, s29, v53
    v_lshlrev_b32 v28, 16, v54
    v_and_b32 v29, s29, v54
    v_lshlrev_b32 v30, 16, v55
    v_and_b32 v31, s29, v55
    v_pk_fma_f32 v[8:9], v[24:25], v[122:123], v[8:9] op_sel_hi:[1,0,1]
    v_pk_fma_f32 v[16:17], v[24:25], v[122:123], v[16:17] op_sel:[0,1,0] op_sel_hi:[1,1,1]
    v_pk_fma_f32 v[10:11], v[26:27], v[122:123], v[10:11] op_sel_hi:[1,0,1]
    v_pk_fma_f32 v[18:19], v[26:27], v[122:123], v[18:19] op_sel:[0,1,0] op_sel_hi:[1,1,1]
    v_pk_fma_f32 v[12:13], v[28:29], v[122:123], v[12:13] op_sel_hi:[1,0,1]
    v_pk_fma_f32 v[20:21], v[28:29], v[122:123], v[20:21] op_sel:[0,1,0] op_sel_hi:[1,1,1]
    v_pk_fma_f32 v[14:15], v[30:31], v[122:123], v[14:15] op_sel_hi:[1,0,1]
    v_pk_fma_f32 v[22:23], v[30:31], v[122:123], v[22:23] op_sel:[0,1,0] op_sel_hi:[1,1,1]
    s_waitcnt vmcnt(13)
    v_lshlrev_b32 v24, 16, v56
    v_and_b32 v25, s29, v56
    v_lshlrev_b32 v26, 16, v57
    v_and_b32 v27, s29, v57
    v_lshlrev_b32 v28, 16, v58
    v_and_b32 v29, s29, v58
    v_lshlrev_b32 v30, 16, v59
    v_and_b32 v31, s29, v59
    v_pk_fma_f32 v[8:9], v[24:25], v[124:125], v[8:9] op_sel_hi:[1,0,1]
    v_pk_fma_f32 v[16:17], v[24:25], v[124:125], v[16:17] op_sel:[0,1,0] op_sel_hi:[1,1,1]
    v_pk_fma_f32 v[10:11], v[26:27], v[124:125], v[10:11] op_sel_hi:[1,0,1]
    v_pk_fma_f32 v[18:19], v[26:27], v[124:125], v[18:19] op_sel:[0,1,0] op_sel_hi:[1,1,1]
    v_pk_fma_f32 v[12:13], v[28:29], v[124:125], v[12:13] op_sel_hi:[1,0,1]
    v_pk_fma_f32 v[20:21], v[28:29], v[124:125], v[20:21] op_sel:[0,1,0] op_sel_hi:[1,1,1]
    v_pk_fma_f32 v[14:15], v[30:31], v[124:125], v[14:15] op_sel_hi:[1,0,1]
    v_pk_fma_f32 v[22:23], v[30:31], v[124:125], v[22:23] op_sel:[0,1,0] op_sel_hi:[1,1,1]
    s_waitcnt vmcnt(12)
    v_lshlrev_b32 v24, 16, v60
    v_and_b32 v25, s29, v60
    v_lshlrev_b32 v26, 16, v61
    v_and_b32 v27, s29, v61
    v_lshlrev_b32 v28, 16, v62
    v_and_b32 v29, s29, v62
    v_lshlrev_b32 v30, 16, v63
    v_and_b32 v31, s29, v63
    v_pk_fma_f32 v[8:9], v[24:25], v[126:127], v[8:9] op_sel_hi:[1,0,1]
    v_pk_fma_f32 v[16:17], v[24:25], v[126:127], v[16:17] op_sel:[0,1,0] op_sel_hi:[1,1,1]
    v_pk_fma_f32 v[10:11], v[26:27], v[126:127], v[10:11] op_sel_hi:[1,0,1]
    v_pk_fma_f32 v[18:19], v[26:27], v[126:127], v[18:19] op_sel:[0,1,0] op_sel_hi:[1,1,1]
    v_pk_fma_f32 v[12:13], v[28:29], v[126:127], v[12:13] op_sel_hi:[1,0,1]
    v_pk_fma_f32 v[20:21], v[28:29], v[126:127], v[20:21] op_sel:[0,1,0] op_sel_hi:[1,1,1]
    v_pk_fma_f32 v[14:15], v[30:31], v[126:127], v[14:15] op_sel_hi:[1,0,1]
    v_pk_fma_f32 v[22:23], v[30:31], v[126:127], v[22:23] op_sel:[0,1,0] op_sel_hi:[1,1,1]
    s_waitcnt vmcnt(11)
    v_lshlrev_b32 v24, 16, v64
    v_and_b32 v25, s29, v64
    v_lshlrev_b32 v26, 16, v65
    v_and_b32 v27, s29, v65
    v_lshlrev_b32 v28, 16, v66
    v_and_b32 v29, s29, v66
    v_lshlrev_b32 v30, 16, v67
    v_and_b32 v31, s29, v67
    v_pk_fma_f32 v[8:9], v[24:25], v[128:129], v[8:9] op_sel_hi:[1,0,1]
    v_pk_fma_f32 v[16:17], v[24:25], v[128:129], v[16:17] op_sel:[0,1,0] op_sel_hi:[1,1,1]
    v_pk_fma_f32 v[10:11], v[26:27], v[128:129], v[10:11] op_sel_hi:[1,0,1]
    v_pk_fma_f32 v[18:19], v[26:27], v[128:129], v[18:19] op_sel:[0,1,0] op_sel_hi:[1,1,1]
    v_pk_fma_f32 v[12:13], v[28:29], v[128:129], v[12:13] op_sel_hi:[1,0,1]
    v_pk_fma_f32 v[20:21], v[28:29], v[128:129], v[20:21] op_sel:[0,1,0] op_sel_hi:[1,1,1]
    v_pk_fma_f32 v[14:15], v[30:31], v[128:129], v[14:15] op_sel_hi:[1,0,1]
    v_pk_fma_f32 v[22:23], v[30:31], v[128:129], v[22:23] op_sel:[0,1,0] op_sel_hi:[1,1,1]
    s_waitcnt vmcnt(10)
    v_lshlrev_b32 v24, 16, v68
    v_and_b32 v25, s29, v68
    v_lshlrev_b32 v26, 16, v69
    v_and_b32 v27, s29, v69
    v_lshlrev_b32 v28, 16, v70
    v_and_b32 v29, s29, v70
    v_lshlrev_b32 v30, 16, v71
    v_and_b32 v31, s29, v71
    v_pk_fma_f32 v[8:9], v[24:25], v[130:131], v[8:9] op_sel_hi:[1,0,1]
    v_pk_fma_f32 v[16:17], v[24:25], v[130:131], v[16:17] op_sel:[0,1,0] op_sel_hi:[1,1,1]
    v_pk_fma_f32 v[10:11], v[26:27], v[130:131], v[10:11] op_sel_hi:[1,0,1]
    v_pk_fma_f32 v[18:19], v[26:27], v[130:131], v[18:19] op_sel:[0,1,0] op_sel_hi:[1,1,1]
    v_pk_fma_f32 v[12:13], v[28:29], v[130:131], v[12:13] op_sel_hi:[1,0,1]
    v_pk_fma_f32 v[20:21], v[28:29], v[130:131], v[20:21] op_sel:[0,1,0] op_sel_hi:[1,1,1]
    v_pk_fma_f32 v[14:15], v[30:31], v[130:131], v[14:15] op_sel_hi:[1,0,1]
    v_pk_fma_f32 v[22:23], v[30:31], v[130:131], v[22:23] op_sel:[0,1,0] op_sel_hi:[1,1,1]
    s_waitcnt vmcnt(9)
    v_lshlrev_b32 v24, 16, v72
    v_and_b32 v25, s29, v72
    v_lshlrev_b32 v26, 16, v73
    v_and_b32 v27, s29, v73
    v_lshlrev_b32 v28, 16, v74
    v_and_b32 v29, s29, v74
    v_lshlrev_b32 v30, 16, v75
    v_and_b32 v31, s29, v75
    v_pk_fma_f32 v[8:9], v[24:25], v[132:133], v[8:9] op_sel_hi:[1,0,1]
    v_pk_fma_f32 v[16:17], v[24:25], v[132:133], v[16:17] op_sel:[0,1,0] op_sel_hi:[1,1,1]
    v_pk_fma_f32 v[10:11], v[26:27], v[132:133], v[10:11] op_sel_hi:[1,0,1]
    v_pk_fma_f32 v[18:19], v[26:27], v[132:133], v[18:19] op_sel:[0,1,0] op_sel_hi:[1,1,1]
    v_pk_fma_f32 v[12:13], v[28:29], v[132:133], v[12:13] op_sel_hi:[1,0,1]
    v_pk_fma_f32 v[20:21], v[28:29], v[132:133], v[20:21] op_sel:[0,1,0] op_sel_hi:[1,1,1]
    v_pk_fma_f32 v[14:15], v[30:31], v[132:133], v[14:15] op_sel_hi:[1,0,1]
    v_pk_fma_f32 v[22:23], v[30:31], v[132:133], v[22:23] op_sel:[0,1,0] op_sel_hi:[1,1,1]
    s_waitcnt vmcnt(8)
    v_lshlrev_b32 v24, 16, v76
    v_and_b32 v25, s29, v76
    v_lshlrev_b32 v26, 16, v77
    v_and_b32 v27, s29, v77
    v_lshlrev_b32 v28, 16, v78
    v_and_b32 v29, s29, v78
    v_lshlrev_b32 v30, 16, v79
    v_and_b32 v31, s29, v79
    v_pk_fma_f32 v[8:9], v[24:25], v[134:135], v[8:9] op_sel_hi:[1,0,1]
    v_pk_fma_f32 v[16:17], v[24:25], v[134:135], v[16:17] op_sel:[0,1,0] op_sel_hi:[1,1,1]
    v_pk_fma_f32 v[10:11], v[26:27], v[134:135], v[10:11] op_sel_hi:[1,0,1]
    v_pk_fma_f32 v[18:19], v[26:27], v[134:135], v[18:19] op_sel:[0,1,0] op_sel_hi:[1,1,1]
    v_pk_fma_f32 v[12:13], v[28:29], v[134:135], v[12:13] op_sel_hi:[1,0,1]
    v_pk_fma_f32 v[20:21], v[28:29], v[134:135], v[20:21] op_sel:[0,1,0] op_sel_hi:[1,1,1]
    v_pk_fma_f32 v[14:15], v[30:31], v[134:135], v[14:15] op_sel_hi:[1,0,1]
    v_pk_fma_f32 v[22:23], v[30:31], v[134:135], v[22:23] op_sel:[0,1,0] op_sel_hi:[1,1,1]
    s_waitcnt vmcnt(7)
    v_lshlrev_b32 v24, 16, v80
    v_and_b32 v25, s29, v80
    v_lshlrev_b32 v26, 16, v81
    v_and_b32 v27, s29, v81
    v_lshlrev_b32 v28, 16, v82
    v_and_b32 v29, s29, v82
    v_lshlrev_b32 v30, 16, v83
    v_and_b32 v31, s29, v83
    v_pk_fma_f32 v[8:9], v[24:25], v[136:137], v[8:9] op_sel_hi:[1,0,1]
    v_pk_fma_f32 v[16:17], v[24:25], v[136:137], v[16:17] op_sel:[0,1,0] op_sel_hi:[1,1,1]
    v_pk_fma_f32 v[10:11], v[26:27], v[136:137], v[10:11] op_sel_hi:[1,0,1]
    v_pk_fma_f32 v[18:19], v[26:27], v[136:137], v[18:19] op_sel:[0,1,0] op_sel_hi:[1,1,1]
    v_pk_fma_f32 v[12:13], v[28:29], v[136:137], v[12:13] op_sel_hi:[1,0,1]
    v_pk_fma_f32 v[20:21], v[28:29], v[136:137], v[20:21] op_sel:[0,1,0] op_sel_hi:[1,1,1]
    v_pk_fma_f32 v[14:15], v[30:31], v[136:137], v[14:15] op_sel_hi:[1,0,1]
    v_pk_fma_f32 v[22:23], v[30:31], v[136:137], v[22:23] op_sel:[0,1,0] op_sel_hi:[1,1,1]
    s_waitcnt vmcnt(6)
    v_lshlrev_b32 v24, 16, v84
    v_and_b32 v25, s29, v84
    v_lshlrev_b32 v26, 16, v85
    v_and_b32 v27, s29, v85
    v_lshlrev_b32 v28, 16, v86
    v_and_b32 v29, s29, v86
    v_lshlrev_b32 v30, 16, v87
    v_and_b32 v31, s29, v87
    v_pk_fma_f32 v[8:9], v[24:25], v[138:139], v[8:9] op_sel_hi:[1,0,1]
    v_pk_fma_f32 v[16:17], v[24:25], v[138:139], v[16:17] op_sel:[0,1,0] op_sel_hi:[1,1,1]
    v_pk_fma_f32 v[10:11], v[26:27], v[138:139], v[10:11] op_sel_hi:[1,0,1]
    v_pk_fma_f32 v[18:19], v[26:27], v[138:139], v[18:19] op_sel:[0,1,0] op_sel_hi:[1,1,1]
    v_pk_fma_f32 v[12:13], v[28:29], v[138:139], v[12:13] op_sel_hi:[1,0,1]
    v_pk_fma_f32 v[20:21], v[28:29], v[138:139], v[20:21] op_sel:[0,1,0] op_sel_hi:[1,1,1]
    v_pk_fma_f32 v[14:15], v[30:31], v[138:139], v[14:15] op_sel_hi:[1,0,1]
    v_pk_fma_f32 v[22:23], v[30:31], v[138:139], v[22:23] op_sel:[0,1,0] op_sel_hi:[1,1,1]
    s_waitcnt vmcnt(5)
    v_lshlrev_b32 v24, 16, v88
    v_and_b32 v25, s29, v88
    v_lshlrev_b32 v26, 16, v89
    v_and_b32 v27, s29, v89
    v_lshlrev_b32 v28, 16, v90
    v_and_b32 v29, s29, v90
    v_lshlrev_b32 v30, 16, v91
    v_and_b32 v31, s29, v91
    v_pk_fma_f32 v[8:9], v[24:25], v[140:141], v[8:9] op_sel_hi:[1,0,1]
    v_pk_fma_f32 v[16:17], v[24:25], v[140:141], v[16:17] op_sel:[0,1,0] op_sel_hi:[1,1,1]
    v_pk_fma_f32 v[10:11], v[26:27], v[140:141], v[10:11] op_sel_hi:[1,0,1]
    v_pk_fma_f32 v[18:19], v[26:27], v[140:141], v[18:19] op_sel:[0,1,0] op_sel_hi:[1,1,1]
    v_pk_fma_f32 v[12:13], v[28:29], v[140:141], v[12:13] op_sel_hi:[1,0,1]
    v_pk_fma_f32 v[20:21], v[28:29], v[140:141], v[20:21] op_sel:[0,1,0] op_sel_hi:[1,1,1]
    v_pk_fma_f32 v[14:15], v[30:31], v[140:141], v[14:15] op_sel_hi:[1,0,1]
    v_pk_fma_f32 v[22:23], v[30:31], v[140:141], v[22:23] op_sel:[0,1,0] op_sel_hi:[1,1,1]
    s_waitcnt vmcnt(4)
    v_lshlrev_b32 v24, 16, v92
    v_and_b32 v25, s29, v92
    v_lshlrev_b32 v26, 16, v93
    v_and_b32 v27, s29, v93
    v_lshlrev_b32 v28, 16, v94
    v_and_b32 v29, s29, v94
    v_lshlrev_b32 v30, 16, v95
    v_and_b32 v31, s29, v95
    v_pk_fma_f32 v[8:9], v[24:25], v[142:143], v[8:9] op_sel_hi:[1,0,1]
    v_pk_fma_f32 v[16:17], v[24:25], v[142:143], v[16:17] op_sel:[0,1,0] op_sel_hi:[1,1,1]
    v_pk_fma_f32 v[10:11], v[26:27], v[142:143], v[10:11] op_sel_hi:[1,0,1]
    v_pk_fma_f32 v[18:19], v[26:27], v[142:143], v[18:19] op_sel:[0,1,0] op_sel_hi:[1,1,1]
    v_pk_fma_f32 v[12:13], v[28:29], v[142:143], v[12:13] op_sel_hi:[1,0,1]
    v_pk_fma_f32 v[20:21], v[28:29], v[142:143], v[20:21] op_sel:[0,1,0] op_sel_hi:[1,1,1]
    v_pk_fma_f32 v[14:15], v[30:31], v[142:143], v[14:15] op_sel_hi:[1,0,1]
    v_pk_fma_f32 v[22:23], v[30:31], v[142:143], v[22:23] op_sel:[0,1,0] op_sel_hi:[1,1,1]
    s_waitcnt vmcnt(3)
    v_lshlrev_b32 v24, 16, v96
    v_and_b32 v25, s29, v96
    v_lshlrev_b32 v26, 16, v97
    v_and_b32 v27, s29, v97
    v_lshlrev_b32 v28, 16, v98
    v_and_b32 v29, s29, v98
    v_lshlrev_b32 v30, 16, v99
    v_and_b32 v31, s29, v99
    v_pk_fma_f32 v[8:9], v[24:25], v[144:145], v[8:9] op_sel_hi:[1,0,1]
    v_pk_fma_f32 v[16:17], v[24:25], v[144:145], v[16:17] op_sel:[0,1,0] op_sel_hi:[1,1,1]
    v_pk_fma_f32 v[10:11], v[26:27], v[144:145], v[10:11] op_sel_hi:[1,0,1]
    v_pk_fma_f32 v[18:19], v[26:27], v[144:145], v[18:19] op_sel:[0,1,0] op_sel_hi:[1,1,1]
    v_pk_fma_f32 v[12:13], v[28:29], v[144:145], v[12:13] op_sel_hi:[1,0,1]
    v_pk_fma_f32 v[20:21], v[28:29], v[144:145], v[20:21] op_sel:[0,1,0] op_sel_hi:[1,1,1]
    v_pk_fma_f32 v[14:15], v[30:31], v[144:145], v[14:15] op_sel_hi:[1,0,1]
    v_pk_fma_f32 v[22:23], v[30:31], v[144:145], v[22:23] op_sel:[0,1,0] op_sel_hi:[1,1,1]
    s_waitcnt vmcnt(2)
    v_lshlrev_b32 v24, 16, v100
    v_and_b32 v25, s29, v100
    v_lshlrev_b32 v26, 16, v101
    v_and_b32 v27, s29, v101
    v_lshlrev_b32 v28, 16, v102
    v_and_b32 v29, s29, v102
    v_lshlrev_b32 v30, 16, v103
    v_and_b32 v31, s29, v103
    v_pk_fma_f32 v[8:9], v[24:25], v[146:147], v[8:9] op_sel_hi:[1,0,1]
    v_pk_fma_f32 v[16:17], v[24:25], v[146:147], v[16:17] op_sel:[0,1,0] op_sel_hi:[1,1,1]
    v_pk_fma_f32 v[10:11], v[26:27], v[146:147], v[10:11] op_sel_hi:[1,0,1]
    v_pk_fma_f32 v[18:19], v[26:27], v[146:147], v[18:19] op_sel:[0,1,0] op_sel_hi:[1,1,1]
    v_pk_fma_f32 v[12:13], v[28:29], v[146:147], v[12:13] op_sel_hi:[1,0,1]
    v_pk_fma_f32 v[20:21], v[28:29], v[146:147], v[20:21] op_sel:[0,1,0] op_sel_hi:[1,1,1]
    v_pk_fma_f32 v[14:15], v[30:31], v[146:147], v[14:15] op_sel_hi:[1,0,1]
    v_pk_fma_f32 v[22:23], v[30:31], v[146:147], v[22:23] op_sel:[0,1,0] op_sel_hi:[1,1,1]
    s_waitcnt vmcnt(1)
    v_lshlrev_b32 v24, 16, v104
    v_and_b32 v25, s29, v104
    v_lshlrev_b32 v26, 16, v105
    v_and_b32 v27, s29, v105
    v_lshlrev_b32 v28, 16, v106
    v_and_b32 v29, s29, v106
    v_lshlrev_b32 v30, 16, v107
    v_and_b32 v31, s29, v107
    v_pk_fma_f32 v[8:9], v[24:25], v[148:149], v[8:9] op_sel_hi:[1,0,1]
    v_pk_fma_f32 v[16:17], v[24:25], v[148:149], v[16:17] op_sel:[0,1,0] op_sel_hi:[1,1,1]
    v_pk_fma_f32 v[10:11], v[26:27], v[148:149], v[10:11] op_sel_hi:[1,0,1]
    v_pk_fma_f32 v[18:19], v[26:27], v[148:149], v[18:19] op_sel:[0,1,0] op_sel_hi:[1,1,1]
    v_pk_fma_f32 v[12:13], v[28:29], v[148:149], v[12:13] op_sel_hi:[1,0,1]
    v_pk_fma_f32 v[20:21], v[28:29], v[148:149], v[20:21] op_sel:[0,1,0] op_sel_hi:[1,1,1]
    v_pk_fma_f32 v[14:15], v[30:31], v[148:149], v[14:15] op_sel_hi:[1,0,1]
    v_pk_fma_f32 v[22:23], v[30:31], v[148:149], v[22:23] op_sel:[0,1,0] op_sel_hi:[1,1,1]
    s_waitcnt vmcnt(0)
    v_lshlrev_b32 v24, 16, v108
    v_and_b32 v25, s29, v108
    v_lshlrev_b32 v26, 16, v109
    v_and_b32 v27, s29, v109
    v_lshlrev_b32 v28, 16, v110
    v_and_b32 v29, s29, v110
    v_lshlrev_b32 v30, 16, v111
    v_and_b32 v31, s29, v111
    v_pk_fma_f32 v[8:9], v[24:25], v[150:151], v[8:9] op_sel_hi:[1,0,1]
    v_pk_fma_f32 v[16:17], v[24:25], v[150:151], v[16:17] op_sel:[0,1,0] op_sel_hi:[1,1,1]
    v_pk_fma_f32 v[10:11], v[26:27], v[150:151], v[10:11] op_sel_hi:[1,0,1]
    v_pk_fma_f32 v[18:19], v[26:27], v[150:151], v[18:19] op_sel:[0,1,0] op_sel_hi:[1,1,1]
    v_pk_fma_f32 v[12:13], v[28:29], v[150:151], v[12:13] op_sel_hi:[1,0,1]
    v_pk_fma_f32 v[20:21], v[28:29], v[150:151], v[20:21] op_sel:[0,1,0] op_sel_hi:[1,1,1]
    v_pk_fma_f32 v[14:15], v[30:31], v[150:151], v[14:15] op_sel_hi:[1,0,1]
    v_pk_fma_f32 v[22:23], v[30:31], v[150:151], v[22:23] op_sel:[0,1,0] op_sel_hi:[1,1,1]
    v_lshlrev_b32 v4, 9, v1
    v_lshl_add_u32 v4, v2, 5, v4
    ds_write_b128 v4, v[8:11]
    ds_write_b128 v4, v[12:15] offset:16
    ds_write_b128 v4, v[16:19] offset:256
    ds_write_b128 v4, v[20:23] offset:272
    v_and_b32 v6, 63, v0
    v_lshlrev_b32 v6, 2, v6
    v_lshl_add_u32 v5, v7, 12, v6
    s_waitcnt lgkmcnt(0)
    ds_read2st64_b32 v[8:9], v5 offset0:0 offset1:1
    ds_read2st64_b32 v[10:11], v5 offset0:2 offset1:3
    ds_read2st64_b32 v[12:13], v5 offset0:4 offset1:5
    ds_read2st64_b32 v[14:15], v5 offset0:6 offset1:7
    ds_read2st64_b32 v[16:17], v5 offset0:8 offset1:9
    ds_read2st64_b32 v[18:19], v5 offset0:10 offset1:11
    ds_read2st64_b32 v[20:21], v5 offset0:12 offset1:13
    ds_read2st64_b32 v[22:23], v5 offset0:14 offset1:15
    s_waitcnt lgkmcnt(0)
    v_pk_add_f32 v[8:9], v[8:9], v[10:11]
    v_pk_add_f32 v[8:9], v[8:9], v[12:13]
    v_pk_add_f32 v[8:9], v[8:9], v[14:15]
    v_pk_add_f32 v[8:9], v[8:9], v[16:17]
    v_pk_add_f32 v[8:9], v[8:9], v[18:19]
    v_pk_add_f32 v[8:9], v[8:9], v[20:21]
    v_pk_add_f32 v[8:9], v[8:9], v[22:23]
    v_lshlrev_b32 v5, 3, v0
    ds_write_b64 v5, v[8:9] offset:16384
    v_lshlrev_b32 v5, 1, v6
    s_waitcnt lgkmcnt(0)
    s_barrier
    ds_read_b64 v[8:9], v5 offset:16384
    ds_read_b64 v[10:11], v5 offset:16896
    ds_read_b64 v[12:13], v5 offset:17408
    ds_read_b64 v[14:15], v5 offset:17920
    s_waitcnt lgkmcnt(0)
    v_pk_add_f32 v[8:9], v[8:9], v[10:11]
    v_pk_add_f32 v[8:9], v[8:9], v[12:13]
    v_pk_add_f32 v[8:9], v[8:9], v[14:15]
    v_cvt_pk_bf16_f32 v22, v8, v8
    v_lshlrev_b32 v22, 16, v22
    v_sub_f32 v23, v8, v22
    v_cvt_pk_bf16_f32 v8, v22, v23
    v_cvt_pk_bf16_f32 v22, v9, v9
    v_lshlrev_b32 v22, 16, v22
    v_sub_f32 v23, v9, v22
    v_cvt_pk_bf16_f32 v9, v22, v23
    s_mul_i32 s7, s6, 27648
    s_lshl_b32 s14, s4, 10
    s_add_u32 s7, s7, s14
    v_mov_b32 v10, 0
    v_mov_b32 v11, 0
    v_lshlrev_b32 v6, 2, v6
    s_cmp_lg_u32 s3, 0
    s_cbranch_scc1 B_end
    buffer_store_dwordx4 v[8:11], v6, s[24:27], s7 offen
    s_endpgm
B_m:
    s_load_dwordx4 s[8:11], s[0:1], 88
    s_load_dwordx2 s[12:13], s[0:1], 120
    s_setprio 0
    s_and_b32 s5, s4, 3
    s_lshr_b32 s4, s4, 2
    v_lshrrev_b32 v1, 3, v0
    v_and_b32 v2, 7, v0
    v_mul_u32_u24 v3, 7680, v1
    v_lshl_add_u32 v3, v2, 4, v3
    v_lshlrev_b32 v4, 1, v1
    s_mul_i32 s6, s5, 1228800
    s_lshl_b32 s7, s4, 7
    s_add_u32 s6, s6, s7
    s_mul_i32 s7, s5, 320
    s_waitcnt lgkmcnt(0)
    s_mov_b32 s16, s8
    s_mov_b32 s17, s9
    s_mov_b32 s18, 0x500
    s_mov_b32 s19, 0x00020000
    s_mov_b32 s20, s10
    s_mov_b32 s21, s11
    s_mov_b32 s22, 0x4b0000
    s_mov_b32 s23, 0x00020000
    s_add_u32 s24, s12, 0x790000
    s_addc_u32 s25, s13, 0
    s_mov_b32 s26, 0xf000
    s_mov_b32 s27, 0x00020000
    buffer_load_ushort v8, v4, s[16:19], s7 offen offset:0
    buffer_load_ushort v9, v4, s[16:19], s7 offen offset:64
    buffer_load_ushort v10, v4, s[16:19], s7 offen offset:128
    buffer_load_ushort v11, v4, s[16:19], s7 offen offset:192
    buffer_load_ushort v12, v4, s[16:19], s7 offen offset:256
    buffer_load_dwordx4 v[16:19], v3, s[20:23], s6 offen
    s_add_u32 s6, s6, 245760
    buffer_load_dwordx4 v[20:23], v3, s[20:23], s6 offen
    s_add_u32 s6, s6, 245760
    buffer_load_dwordx4 v[24:27], v3, s[20:23], s6 offen
    s_add_u32 s6, s6, 245760
    buffer_load_dwordx4 v[28:31], v3, s[20:23], s6 offen
    s_add_u32 s6, s6, 245760
    buffer_load_dwordx4 v[32:35], v3, s[20:23], s6 offen
    s_add_u32 s6, s6, 245760
    s_mov_b32 s28, 0x3fb8aa3b
    s_mov_b32 s29, 0xffff0000
    s_waitcnt vmcnt(5)
    v_lshlrev_b32 v8, 16, v8
    v_mul_f32 v13, s28, v8
    v_exp_f32 v13, -v13
    s_nop 0
    v_add_f32 v13, 1.0, v13
    v_rcp_f32 v13, v13
    s_nop 0
    v_mul_f32 v8, v8, v13
    v_cvt_pk_bf16_f32 v8, v8, v8
    v_lshlrev_b32 v8, 16, v8
    v_lshlrev_b32 v9, 16, v9
    v_mul_f32 v13, s28, v9
    v_exp_f32 v13, -v13
    s_nop 0
    v_add_f32 v13, 1.0, v13
    v_rcp_f32 v13, v13
    s_nop 0
    v_mul_f32 v9, v9, v13
    v_cvt_pk_bf16_f32 v9, v9, v9
    v_lshlrev_b32 v9, 16, v9
    v_lshlrev_b32 v10, 16, v10
    v_mul_f32 v13, s28, v10
    v_exp_f32 v13, -v13
    s_nop 0
    v_add_f32 v13, 1.0, v13
    v_rcp_f32 v13, v13
    s_nop 0
    v_mul_f32 v10, v10, v13
    v_cvt_pk_bf16_f32 v10, v10, v10
    v_lshlrev_b32 v10, 16, v10
    v_lshlrev_b32 v11, 16, v11
    v_mul_f32 v13, s28, v11
    v_exp_f32 v13, -v13
    s_nop 0
    v_add_f32 v13, 1.0, v13
    v_rcp_f32 v13, v13
    s_nop 0
    v_mul_f32 v11, v11, v13
    v_cvt_pk_bf16_f32 v11, v11, v11
    v_lshlrev_b32 v11, 16, v11
    v_lshlrev_b32 v12, 16, v12
    v_mul_f32 v13, s28, v12
    v_exp_f32 v13, -v13
    s_nop 0
    v_add_f32 v13, 1.0, v13
    v_rcp_f32 v13, v13
    s_nop 0
    v_mul_f32 v12, v12, v13
    v_cvt_pk_bf16_f32 v12, v12, v12
    v_lshlrev_b32 v12, 16, v12
    s_waitcnt vmcnt(4)
    v_lshlrev_b32 v13, 16, v16
    v_and_b32 v14, s29, v16
    v_mul_f32 v40, v13, v8
    v_mul_f32 v41, v14, v8
    v_lshlrev_b32 v13, 16, v17
    v_and_b32 v14, s29, v17
    v_mul_f32 v42, v13, v8
    v_mul_f32 v43, v14, v8
    v_lshlrev_b32 v13, 16, v18
    v_and_b32 v14, s29, v18
    v_mul_f32 v44, v13, v8
    v_mul_f32 v45, v14, v8
    v_lshlrev_b32 v13, 16, v19
    v_and_b32 v14, s29, v19
    v_mul_f32 v46, v13, v8
    v_mul_f32 v47, v14, v8
    s_waitcnt vmcnt(3)
    v_lshlrev_b32 v13, 16, v20
    v_and_b32 v14, s29, v20
    v_fmac_f32 v40, v13, v9
    v_fmac_f32 v41, v14, v9
    v_lshlrev_b32 v13, 16, v21
    v_and_b32 v14, s29, v21
    v_fmac_f32 v42, v13, v9
    v_fmac_f32 v43, v14, v9
    v_lshlrev_b32 v13, 16, v22
    v_and_b32 v14, s29, v22
    v_fmac_f32 v44, v13, v9
    v_fmac_f32 v45, v14, v9
    v_lshlrev_b32 v13, 16, v23
    v_and_b32 v14, s29, v23
    v_fmac_f32 v46, v13, v9
    v_fmac_f32 v47, v14, v9
    s_waitcnt vmcnt(2)
    v_lshlrev_b32 v13, 16, v24
    v_and_b32 v14, s29, v24
    v_fmac_f32 v40, v13, v10
    v_fmac_f32 v41, v14, v10
    v_lshlrev_b32 v13, 16, v25
    v_and_b32 v14, s29, v25
    v_fmac_f32 v42, v13, v10
    v_fmac_f32 v43, v14, v10
    v_lshlrev_b32 v13, 16, v26
    v_and_b32 v14, s29, v26
    v_fmac_f32 v44, v13, v10
    v_fmac_f32 v45, v14, v10
    v_lshlrev_b32 v13, 16, v27
    v_and_b32 v14, s29, v27
    v_fmac_f32 v46, v13, v10
    v_fmac_f32 v47, v14, v10
    s_waitcnt vmcnt(1)
    v_lshlrev_b32 v13, 16, v28
    v_and_b32 v14, s29, v28
    v_fmac_f32 v40, v13, v11
    v_fmac_f32 v41, v14, v11
    v_lshlrev_b32 v13, 16, v29
    v_and_b32 v14, s29, v29
    v_fmac_f32 v42, v13, v11
    v_fmac_f32 v43, v14, v11
    v_lshlrev_b32 v13, 16, v30
    v_and_b32 v14, s29, v30
    v_fmac_f32 v44, v13, v11
    v_fmac_f32 v45, v14, v11
    v_lshlrev_b32 v13, 16, v31
    v_and_b32 v14, s29, v31
    v_fmac_f32 v46, v13, v11
    v_fmac_f32 v47, v14, v11
    s_waitcnt vmcnt(0)
    v_lshlrev_b32 v13, 16, v32
    v_and_b32 v14, s29, v32
    v_fmac_f32 v40, v13, v12
    v_fmac_f32 v41, v14, v12
    v_lshlrev_b32 v13, 16, v33
    v_and_b32 v14, s29, v33
    v_fmac_f32 v42, v13, v12
    v_fmac_f32 v43, v14, v12
    v_lshlrev_b32 v13, 16, v34
    v_and_b32 v14, s29, v34
    v_fmac_f32 v44, v13, v12
    v_fmac_f32 v45, v14, v12
    v_lshlrev_b32 v13, 16, v35
    v_and_b32 v14, s29, v35
    v_fmac_f32 v46, v13, v12
    v_fmac_f32 v47, v14, v12
    v_lshlrev_b32 v5, 5, v0
    ds_write_b128 v5, v[40:43]
    ds_write_b128 v5, v[44:47] offset:16
    v_and_b32 v6, 63, v0
    v_lshrrev_b32 v7, 6, v0
    v_lshlrev_b32 v6, 2, v6
    v_lshl_add_u32 v5, v7, 11, v6
    s_waitcnt lgkmcnt(0)
    ds_read_b32 v16, v5 offset:0
    ds_read_b32 v17, v5 offset:256
    ds_read_b32 v18, v5 offset:512
    ds_read_b32 v19, v5 offset:768
    ds_read_b32 v20, v5 offset:1024
    ds_read_b32 v21, v5 offset:1280
    ds_read_b32 v22, v5 offset:1536
    ds_read_b32 v23, v5 offset:1792
    s_waitcnt lgkmcnt(0)
    v_add_f32 v16, v16, v17
    v_add_f32 v16, v16, v18
    v_add_f32 v16, v16, v19
    v_add_f32 v16, v16, v20
    v_add_f32 v16, v16, v21
    v_add_f32 v16, v16, v22
    v_add_f32 v16, v16, v23
    v_lshlrev_b32 v5, 2, v0
    ds_write_b32 v5, v16 offset:8192
    s_waitcnt lgkmcnt(0)
    s_barrier
    ds_read_b32 v16, v6 offset:8192
    ds_read_b32 v17, v6 offset:8448
    ds_read_b32 v18, v6 offset:8704
    ds_read_b32 v19, v6 offset:8960
    s_mul_i32 s6, s5, 15360
    s_lshl_b32 s7, s4, 8
    s_add_u32 s6, s6, s7
    s_waitcnt lgkmcnt(0)
    v_add_f32 v16, v16, v17
    v_add_f32 v18, v18, v19
    v_add_f32 v16, v16, v18
    v_cmp_gt_u32 vcc, 64, v0
    s_and_saveexec_b64 s[30:31], vcc
    s_cbranch_execz B_end
    buffer_store_dword v16, v6, s[24:27], s6 offen
B_end:
    s_endpgm
.globl kc_kernel
.p2align 8
.type kc_kernel,@function
kc_kernel:
    s_cmp_ge_u32 s2, 248
    s_cbranch_scc1 C_end
    s_cmp_lt_u32 s2, 32
    s_cbranch_scc1 C_st
    s_load_dwordx2 s[8:9], s[0:1], 120
    s_load_dwordx4 s[44:47], s[0:1], 64
    s_and_b32 s4, s2, 7
    s_mul_i32 s4, s4, 27
    s_lshr_b32 s5, s2, 3
    s_sub_u32 s5, s5, 4
    s_add_u32 s6, s4, s5
    s_cmp_ge_u32 s6, 108
    s_cselect_b32 s4, 4, 0
    s_cselect_b32 s7, 108, 0
    s_sub_u32 s6, s6, s7
    s_and_b32 s7, s6, 3
    s_add_u32 s4, s4, s7
    s_lshr_b32 s5, s6, 2
    v_lshrrev_b32 v1, 6, v0
    v_and_b32 v0, 63, v0
    s_nop 0
    v_readfirstlane_b32 s3, v1
    s_and_b32 s36, s3, 3
    s_bfe_u32 s37, s3, 0x10002
    v_lshrrev_b32 v6, 3, v0
    v_and_b32 v4, 7, v0
    v_bfe_u32 v5, v0, 4, 1
    v_lshlrev_b32 v5, 1, v5
    v_xor_b32 v4, v4, v5
    v_lshlrev_b32 v4, 4, v4
    v_lshl_add_u32 v2, v6, 7, v4
    v_xor_b32 v3, 64, v2
    v_and_b32 v5, 1, v1
    v_lshlrev_b32 v5, 6, v5
    v_xor_b32 v4, v4, v5
    v_mul_u32_u24 v1, 3456, v6
    v_add_u32 v1, v1, v4
    s_lshl_b32 s11, s4, 9
    s_lshl_b32 s7, s36, 7
    s_add_u32 s11, s11, s7
    s_lshl_b32 s29, s11, 1
    s_mov_b32 s30, s11
    s_lshl_b32 s11, s11, 3
    s_lshl_b32 s7, s37, 16
    s_add_u32 s11, s11, s7
    s_mul_i32 s24, s36, 27648
    s_lshl_b32 s7, s5, 7
    s_add_u32 s24, s24, s7
    s_mul_i32 s26, s37, 24576
    s_lshl_b32 s7, s36, 10
    s_add_u32 s26, s26, s7
    s_add_u32 s25, s36, 2
    s_mul_i32 s25, s25, 24576
    s_lshl_b32 s7, s37, 11
    s_add_u32 s38, s25, s7
    s_waitcnt lgkmcnt(0)
    s_cmp_lt_u32 s3, 8
    s_cbranch_scc1 C_mm
    s_mov_b32 s12, s44
    s_mov_b32 s13, s45
    s_mov_b32 s14, 0x21c000
    s_mov_b32 s15, 0x00020000
    s_mov_b32 s40, s46
    s_mov_b32 s41, s47
    s_mov_b32 s42, 0x21c000
    s_mov_b32 s43, 0x00020000
    s_add_u32 s16, s8, 0x800000
    s_addc_u32 s17, s9, 0
    s_mov_b32 s18, 0x280000
    s_mov_b32 s19, 0x00020000
    s_add_u32 m0, s26, 0
    s_nop 0
    buffer_load_dwordx4 v1, s[12:15], s24 offen lds
    s_add_u32 m0, s38, 0
    s_nop 0
    buffer_load_dwordx4 v2, s[16:19], s11 offen lds
    s_add_u32 s11, s11, 0x8000
    s_add_u32 m0, s26, 24576
    s_nop 0
    buffer_load_dwordx4 v1, s[40:43], s24 offen lds
    s_add_u32 s24, s24, 110592
    s_add_u32 m0, s38, 1024
    s_nop 0
    buffer_load_dwordx4 v3, s[16:19], s11 offen lds
    s_add_u32 s11, s11, 0x8000
    s_add_u32 m0, s38, 2048
    s_nop 0
    buffer_load_dwordx4 v2, s[16:19], s11 offen lds
    s_add_u32 s11, s11, 0x8000
    s_add_u32 m0, s38, 3072
    s_nop 0
    buffer_load_dwordx4 v3, s[16:19], s11 offen lds
    s_add_u32 s11, s11, 0x8000
    s_add_u32 m0, s26, 4096
    s_nop 0
    buffer_load_dwordx4 v1, s[12:15], s24 offen lds
    s_add_u32 m0, s38, 4096
    s_nop 0
    buffer_load_dwordx4 v2, s[16:19], s11 offen lds
    s_add_u32 s11, s11, 0x8000
    s_add_u32 m0, s26, 28672
    s_nop 0
    buffer_load_dwordx4 v1, s[40:43], s24 offen lds
    s_add_u32 s24, s24, 110592
    s_add_u32 m0, s38, 5120
    s_nop 0
    buffer_load_dwordx4 v3, s[16:19], s11 offen lds
    s_add_u32 s11, s11, 0x8000
    s_add_u32 m0, s38, 6144
    s_nop 0
    buffer_load_dwordx4 v2, s[16:19], s11 offen lds
    s_add_u32 s11, s11, 0x8000
    s_add_u32 m0, s38, 7168
    s_nop 0
    buffer_load_dwordx4 v3, s[16:19], s11 offen lds
    s_add_u32 s11, s11, 0x8000
    s_add_u32 m0, s26, 8192
    s_nop 0
    buffer_load_dwordx4 v1, s[12:15], s24 offen lds
    s_add_u32 m0, s38, 8192
    s_nop 0
    buffer_load_dwordx4 v2, s[16:19], s11 offen lds
    s_add_u32 s11, s11, 0x8000
    s_add_u32 m0, s26, 32768
    s_nop 0
    buffer_load_dwordx4 v1, s[40:43], s24 offen lds
    s_add_u32 s24, s24, 110592
    s_add_u32 m0, s38, 9216
    s_nop 0
    buffer_load_dwordx4 v3, s[16:19], s11 offen lds
    s_add_u32 s11, s11, 0x8000
    s_add_u32 m0, s38, 10240
    s_nop 0
    buffer_load_dwordx4 v2, s[16:19], s11 offen lds
    s_add_u32 s11, s11, 0x8000
    s_add_u32 m0, s38, 11264
    s_nop 0
    buffer_load_dwordx4 v3, s[16:19], s11 offen lds
    s_add_u32 s11, s11, 0x8000
    s_waitcnt vmcnt(12)
    s_barrier
    s_add_u32 m0, s26, 12288
    s_nop 0
    buffer_load_dwordx4 v1, s[12:15], s24 offen lds
    s_waitcnt vmcnt(7)
    s_barrier
    s_add_u32 m0, s38, 12288
    s_nop 0
    buffer_load_dwordx4 v2, s[16:19], s11 offen lds
    s_add_u32 s11, s11, 0x8000
    s_add_u32 m0, s26, 36864
    s_nop 0
    buffer_load_dwordx4 v1, s[40:43], s24 offen lds
    s_add_u32 s24, s24, 110592
    s_add_u32 m0, s38, 13312
    s_nop 0
    buffer_load_dwordx4 v3, s[16:19], s11 offen lds
    s_add_u32 s11, s11, 0x8000
    s_add_u32 m0, s38, 14336
    s_nop 0
    buffer_load_dwordx4 v2, s[16:19], s11 offen lds
    s_add_u32 s11, s11, 0x8000
    s_add_u32 m0, s38, 15360
    s_nop 0
    buffer_load_dwordx4 v3, s[16:19], s11 offen lds
    s_add_u32 s11, s11, 0x8000
    s_add_u32 m0, s26, 16384
    s_nop 0
    buffer_load_dwordx4 v1, s[12:15], s24 offen lds
    s_add_u32 m0, s38, 16384
    s_nop 0
    buffer_load_dwordx4 v2, s[16:19], s11 offen lds
    s_add_u32 s11, s11, 0x8000
    s_waitcnt vmcnt(8)
    s_barrier
    s_add_u32 m0, s26, 40960
    s_nop 0
    buffer_load_dwordx4 v1, s[40:43], s24 offen lds
    s_add_u32 s24, s24, 110592
    s_add_u32 m0, s38, 17408
    s_nop 0
    buffer_load_dwordx4 v3, s[16:19], s11 offen lds
    s_add_u32 s11, s11, 0x8000
    s_add_u32 m0, s38, 18432
    s_nop 0
    buffer_load_dwordx4 v2, s[16:19], s11 offen lds
    s_add_u32 s11, s11, 0x8000
    s_add_u32 m0, s38, 19456
    s_nop 0
    buffer_load_dwordx4 v3, s[16:19], s11 offen lds
    s_add_u32 s11, s11, 0x8000
    s_add_u32 m0, s26, 20480
    s_nop 0
    buffer_load_dwordx4 v1, s[12:15], s24 offen lds
    s_add_u32 m0, s38, 20480
    s_nop 0
    buffer_load_dwordx4 v2, s[16:19], s11 offen lds
    s_add_u32 s11, s11, 0x8000
    s_add_u32 m0, s26, 45056
    s_nop 0
    buffer_load_dwordx4 v1, s[40:43], s24 offen lds
    s_add_u32 s24, s24, 110592
    s_waitcnt vmcnt(9)
    s_barrier
    s_add_u32 m0, s38, 21504
    s_nop 0
    buffer_load_dwordx4 v3, s[16:19], s11 offen lds
    s_add_u32 s11, s11, 0x8000
    s_add_u32 m0, s38, 22528
    s_nop 0
    buffer_load_dwordx4 v2, s[16:19], s11 offen lds
    s_add_u32 s11, s11, 0x8000
    s_add_u32 m0, s38, 23552
    s_nop 0
    buffer_load_dwordx4 v3, s[16:19], s11 offen lds
    s_add_u32 s11, s11, 0x8000
    s_add_u32 m0, s26, 0
    s_nop 0
    buffer_load_dwordx4 v1, s[12:15], s24 offen lds
    s_add_u32 m0, s38, 0
    s_nop 0
    buffer_load_dwordx4 v2, s[16:19], s11 offen lds
    s_add_u32 s11, s11, 0x8000
    s_add_u32 m0, s26, 24576
    s_nop 0
    buffer_load_dwordx4 v1, s[40:43], s24 offen lds
    s_add_u32 s24, s24, 110592
    s_add_u32 m0, s38, 1024
    s_nop 0
    buffer_load_dwordx4 v3, s[16:19], s11 offen lds
    s_add_u32 s11, s11, 0x8000
    s_waitcnt vmcnt(10)
    s_barrier
    s_add_u32 m0, s38, 2048
    s_nop 0
    buffer_load_dwordx4 v2, s[16:19], s11 offen lds
    s_add_u32 s11, s11, 0x8000
    s_add_u32 m0, s38, 3072
    s_nop 0
    buffer_load_dwordx4 v3, s[16:19], s11 offen lds
    s_add_u32 s11, s11, 0x8000
    s_add_u32 m0, s26, 4096
    s_nop 0
    buffer_load_dwordx4 v1, s[12:15], s24 offen lds
    s_add_u32 m0, s38, 4096
    s_nop 0
    buffer_load_dwordx4 v2, s[16:19], s11 offen lds
    s_add_u32 s11, s11, 0x8000
    s_add_u32 m0, s26, 28672
    s_nop 0
    buffer_load_dwordx4 v1, s[40:43], s24 offen lds
    s_add_u32 s24, s24, 110592
    s_add_u32 m0, s38, 5120
    s_nop 0
    buffer_load_dwordx4 v3, s[16:19], s11 offen lds
    s_add_u32 s11, s11, 0x8000
    s_add_u32 m0, s38, 6144
    s_nop 0
    buffer_load_dwordx4 v2, s[16:19], s11 offen lds
    s_add_u32 s11, s11, 0x8000
    s_waitcnt vmcnt(11)
    s_barrier
    s_add_u32 m0, s38, 7168
    s_nop 0
    buffer_load_dwordx4 v3, s[16:19], s11 offen lds
    s_add_u32 s11, s11, 0x8000
    s_add_u32 m0, s26, 8192
    s_nop 0
    buffer_load_dwordx4 v1, s[12:15], s24 offen lds
    s_add_u32 m0, s38, 8192
    s_nop 0
    buffer_load_dwordx4 v2, s[16:19], s11 offen lds
    s_add_u32 s11, s11, 0x8000
    s_add_u32 m0, s26, 32768
    s_nop 0
    buffer_load_dwordx4 v1, s[40:43], s24 offen lds
    s_add_u32 s24, s24, 110592
    s_add_u32 m0, s38, 9216
    s_nop 0
    buffer_load_dwordx4 v3, s[16:19], s11 offen lds
    s_add_u32 s11, s11, 0x8000
    s_add_u32 m0, s38, 10240
    s_nop 0
    buffer_load_dwordx4 v2, s[16:19], s11 offen lds
    s_add_u32 s11, s11, 0x8000
    s_add_u32 m0, s38, 11264
    s_nop 0
    buffer_load_dwordx4 v3, s[16:19], s11 offen lds
    s_add_u32 s11, s11, 0x8000
    s_waitcnt vmcnt(12)
    s_barrier
    s_add_u32 m0, s26, 12288
    s_nop 0
    buffer_load_dwordx4 v1, s[12:15], s24 offen lds
    s_add_u32 m0, s38, 12288
    s_nop 0
    buffer_load_dwordx4 v2, s[16:19], s11 offen lds
    s_add_u32 s11, s11, 0x8000
    s_add_u32 m0, s26, 36864
    s_nop 0
    buffer_load_dwordx4 v1, s[40:43], s24 offen lds
    s_add_u32 s24, s24, 110592
    s_add_u32 m0, s38, 13312
    s_nop 0
    buffer_load_dwordx4 v3, s[16:19], s11 offen lds
    s_add_u32 s11, s11, 0x8000
    s_add_u32 m0, s38, 14336
    s_nop 0
    buffer_load_dwordx4 v2, s[16:19], s11 offen lds
    s_add_u32 s11, s11, 0x8000
    s_add_u32 m0, s38, 15360
    s_nop 0
    buffer_load_dwordx4 v3, s[16:19], s11 offen lds
    s_add_u32 s11, s11, 0x8000
    s_add_u32 m0, s26, 16384
    s_nop 0
    buffer_load_dwordx4 v1, s[12:15], s24 offen lds
    s_waitcnt vmcnt(13)
    s_barrier
    s_add_u32 m0, s38, 16384
    s_nop 0
    buffer_load_dwordx4 v2, s[16:19], s11 offen lds
    s_add_u32 s11, s11, 0x8000
    s_add_u32 m0, s26, 40960
    s_nop 0
    buffer_load_dwordx4 v1, s[40:43], s24 offen lds
    s_add_u32 s24, s24, 110592
    s_add_u32 m0, s38, 17408
    s_nop 0
    buffer_load_dwordx4 v3, s[16:19], s11 offen lds
    s_add_u32 s11, s11, 0x8000
    s_add_u32 m0, s38, 18432
    s_nop 0
    buffer_load_dwordx4 v2, s[16:19], s11 offen lds
    s_add_u32 s11, s11, 0x8000
    s_add_u32 m0, s38, 19456
    s_nop 0
    buffer_load_dwordx4 v3, s[16:19], s11 offen lds
    s_add_u32 s11, s11, 0x8000
    s_add_u32 m0, s26, 20480
    s_nop 0
    buffer_load_dwordx4 v1, s[12:15], s24 offen lds
    s_add_u32 m0, s38, 20480
    s_nop 0
    buffer_load_dwordx4 v2, s[16:19], s11 offen lds
    s_add_u32 s11, s11, 0x8000
    s_waitcnt vmcnt(14)
    s_barrier
    s_add_u32 m0, s26, 45056
    s_nop 0
    buffer_load_dwordx4 v1, s[40:43], s24 offen lds
    s_add_u32 s24, s24, 110592
    s_add_u32 m0, s38, 21504
    s_nop 0
    buffer_load_dwordx4 v3, s[16:19], s11 offen lds
    s_add_u32 s11, s11, 0x8000
    s_add_u32 m0, s38, 22528
    s_nop 0
    buffer_load_dwordx4 v2, s[16:19], s11 offen lds
    s_add_u32 s11, s11, 0x8000
    s_add_u32 m0, s38, 23552
    s_nop 0
    buffer_load_dwordx4 v3, s[16:19], s11 offen lds
    s_add_u32 s11, s11, 0x8000
    s_add_u32 m0, s26, 0
    s_nop 0
    buffer_load_dwordx4 v1, s[12:15], s24 offen lds
    s_add_u32 m0, s38, 0
    s_nop 0
    buffer_load_dwordx4 v2, s[16:19], s11 offen lds
    s_add_u32 s11, s11, 0x8000
    s_add_u32 m0, s26, 24576
    s_nop 0
    buffer_load_dwordx4 v1, s[40:43], s24 offen lds
    s_add_u32 s24, s24, 110592
    s_waitcnt vmcnt(15)
    s_barrier
    s_add_u32 m0, s38, 1024
    s_nop 0
    buffer_load_dwordx4 v3, s[16:19], s11 offen lds
    s_add_u32 s11, s11, 0x8000
    s_add_u32 m0, s38, 2048
    s_nop 0
    buffer_load_dwordx4 v2, s[16:19], s11 offen lds
    s_add_u32 s11, s11, 0x8000
    s_add_u32 m0, s38, 3072
    s_nop 0
    buffer_load_dwordx4 v3, s[16:19], s11 offen lds
    s_add_u32 s11, s11, 0x8000
    s_add_u32 m0, s26, 4096
    s_nop 0
    buffer_load_dwordx4 v1, s[12:15], s24 offen lds
    s_add_u32 m0, s38, 4096
    s_nop 0
    buffer_load_dwordx4 v2, s[16:19], s11 offen lds
    s_add_u32 s11, s11, 0x8000
    s_add_u32 m0, s26, 28672
    s_nop 0
    buffer_load_dwordx4 v1, s[40:43], s24 offen lds
    s_add_u32 s24, s24, 110592
    s_add_u32 m0, s38, 5120
    s_nop 0
    buffer_load_dwordx4 v3, s[16:19], s11 offen lds
    s_add_u32 s11, s11, 0x8000
    s_waitcnt vmcnt(16)
    s_barrier
    s_add_u32 m0, s38, 6144
    s_nop 0
    buffer_load_dwordx4 v2, s[16:19], s11 offen lds
    s_add_u32 s11, s11, 0x8000
    s_add_u32 m0, s38, 7168
    s_nop 0
    buffer_load_dwordx4 v3, s[16:19], s11 offen lds
    s_add_u32 s11, s11, 0x8000
    s_add_u32 m0, s26, 8192
    s_nop 0
    buffer_load_dwordx4 v1, s[12:15], s24 offen lds
    s_add_u32 m0, s38, 8192
    s_nop 0
    buffer_load_dwordx4 v2, s[16:19], s11 offen lds
    s_add_u32 s11, s11, 0x8000
    s_add_u32 m0, s26, 32768
    s_nop 0
    buffer_load_dwordx4 v1, s[40:43], s24 offen lds
    s_add_u32 s24, s24, 110592
    s_add_u32 m0, s38, 9216
    s_nop 0
    buffer_load_dwordx4 v3, s[16:19], s11 offen lds
    s_add_u32 s11, s11, 0x8000
    s_add_u32 m0, s38, 10240
    s_nop 0
    buffer_load_dwordx4 v2, s[16:19], s11 offen lds
    s_add_u32 s11, s11, 0x8000
    s_waitcnt vmcnt(17)
    s_barrier
    s_add_u32 m0, s38, 11264
    s_nop 0
    buffer_load_dwordx4 v3, s[16:19], s11 offen lds
    s_add_u32 s11, s11, 0x8000
    s_add_u32 m0, s26, 12288
    s_nop 0
    buffer_load_dwordx4 v1, s[12:15], s24 offen lds
    s_add_u32 m0, s38, 12288
    s_nop 0
    buffer_load_dwordx4 v2, s[16:19], s11 offen lds
    s_add_u32 s11, s11, 0x8000
    s_add_u32 m0, s26, 36864
    s_nop 0
    buffer_load_dwordx4 v1, s[40:43], s24 offen lds
    s_add_u32 s24, s24, 110592
    s_add_u32 m0, s38, 13312
    s_nop 0
    buffer_load_dwordx4 v3, s[16:19], s11 offen lds
    s_add_u32 s11, s11, 0x8000
    s_add_u32 m0, s38, 14336
    s_nop 0
    buffer_load_dwordx4 v2, s[16:19], s11 offen lds
    s_add_u32 s11, s11, 0x8000
    s_add_u32 m0, s38, 15360
    s_nop 0
    buffer_load_dwordx4 v3, s[16:19], s11 offen lds
    s_add_u32 s11, s11, 0x8000
    s_waitcnt vmcnt(18)
    s_barrier
    s_add_u32 m0, s26, 16384
    s_nop 0
    buffer_load_dwordx4 v1, s[12:15], s24 offen lds
    s_add_u32 m0, s38, 16384
    s_nop 0
    buffer_load_dwordx4 v2, s[16:19], s11 offen lds
    s_add_u32 s11, s11, 0x8000
    s_add_u32 m0, s26, 40960
    s_nop 0
    buffer_load_dwordx4 v1, s[40:43], s24 offen lds
    s_add_u32 s24, s24, 110592
    s_add_u32 m0, s38, 17408
    s_nop 0
    buffer_load_dwordx4 v3, s[16:19], s11 offen lds
    s_add_u32 s11, s11, 0x8000
    s_add_u32 m0, s38, 18432
    s_nop 0
    buffer_load_dwordx4 v2, s[16:19], s11 offen lds
    s_add_u32 s11, s11, 0x8000
    s_add_u32 m0, s38, 19456
    s_nop 0
    buffer_load_dwordx4 v3, s[16:19], s11 offen lds
    s_add_u32 s11, s11, 0x8000
    s_add_u32 m0, s26, 20480
    s_nop 0
    buffer_load_dwordx4 v1, s[12:15], s24 offen lds
    s_waitcnt vmcnt(19)
    s_barrier
    s_add_u32 m0, s38, 20480
    s_nop 0
    buffer_load_dwordx4 v2, s[16:19], s11 offen lds
    s_add_u32 s11, s11, 0x8000
    s_add_u32 m0, s26, 45056
    s_nop 0
    buffer_load_dwordx4 v1, s[40:43], s24 offen lds
    s_add_u32 s24, s24, 110592
    s_add_u32 m0, s38, 21504
    s_nop 0
    buffer_load_dwordx4 v3, s[16:19], s11 offen lds
    s_add_u32 s11, s11, 0x8000
    s_add_u32 m0, s38, 22528
    s_nop 0
    buffer_load_dwordx4 v2, s[16:19], s11 offen lds
    s_add_u32 s11, s11, 0x8000
    s_add_u32 m0, s38, 23552
    s_nop 0
    buffer_load_dwordx4 v3, s[16:19], s11 offen lds
    s_add_u32 s11, s11, 0x8000
    s_add_u32 m0, s26, 0
    s_nop 0
    buffer_load_dwordx4 v1, s[12:15], s24 offen lds
    s_add_u32 m0, s38, 0
    s_nop 0
    buffer_load_dwordx4 v2, s[16:19], s11 offen lds
    s_add_u32 s11, s11, 0x8000
    s_waitcnt vmcnt(20)
    s_barrier
    s_add_u32 m0, s26, 24576
    s_nop 0
    buffer_load_dwordx4 v1, s[40:43], s24 offen lds
    s_add_u32 s24, s24, 110592
    s_add_u32 m0, s38, 1024
    s_nop 0
    buffer_load_dwordx4 v3, s[16:19], s11 offen lds
    s_add_u32 s11, s11, 0x8000
    s_add_u32 m0, s38, 2048
    s_nop 0
    buffer_load_dwordx4 v2, s[16:19], s11 offen lds
    s_add_u32 s11, s11, 0x8000
    s_add_u32 m0, s38, 3072
    s_nop 0
    buffer_load_dwordx4 v3, s[16:19], s11 offen lds
    s_add_u32 s11, s11, 0x8000
    s_add_u32 m0, s26, 4096
    s_nop 0
    buffer_load_dwordx4 v1, s[12:15], s24 offen lds
    s_add_u32 m0, s38, 4096
    s_nop 0
    buffer_load_dwordx4 v2, s[16:19], s11 offen lds
    s_add_u32 s11, s11, 0x8000
    s_add_u32 m0, s26, 28672
    s_nop 0
    buffer_load_dwordx4 v1, s[40:43], s24 offen lds
    s_add_u32 s24, s24, 110592
    s_waitcnt vmcnt(21)
    s_barrier
    s_add_u32 m0, s38, 5120
    s_nop 0
    buffer_load_dwordx4 v3, s[16:19], s11 offen lds
    s_add_u32 s11, s11, 0x8000
    s_add_u32 m0, s38, 6144
    s_nop 0
    buffer_load_dwordx4 v2, s[16:19], s11 offen lds
    s_add_u32 s11, s11, 0x8000
    s_add_u32 m0, s38, 7168
    s_nop 0
    buffer_load_dwordx4 v3, s[16:19], s11 offen lds
    s_add_u32 s11, s11, 0x8000
    s_waitcnt vmcnt(18)
    s_barrier
    s_waitcnt vmcnt(12)
    s_barrier
    s_waitcnt vmcnt(6)
    s_barrier
    s_waitcnt vmcnt(0)
    s_barrier
    s_endpgm
C_mm:
    s_add_u32 s20, s8, 0x1000000
    s_addc_u32 s21, s9, 0
    s_mov_b32 s22, 0x6c0000
    s_mov_b32 s23, 0x00020000
    s_add_u32 s32, s8, 0x788000
    s_addc_u32 s33, s9, 0
    s_mov_b32 s34, 0x2000
    s_mov_b32 s35, 0x00020000
    s_add_u32 s44, s8, 0x7a0000
    s_addc_u32 s45, s9, 0
    s_mov_b32 s46, 0xd800
    s_mov_b32 s47, 0x00020000
    v_lshrrev_b32 v4, 4, v0
    v_bfe_u32 v5, v0, 2, 2
    v_lshl_add_u32 v4, v4, 3, v5
    v_lshlrev_b32 v4, 7, v4
    v_and_b32 v5, 3, v0
    v_lshl_add_u32 v4, v5, 3, v4
    v_bfe_u32 v5, v0, 3, 2
    v_lshl_add_u32 v4, v5, 5, v4
    s_lshl_b32 s7, s37, 6
    v_xor_b32 v8, s7, v4
    v_xor_b32 v9, 32, v8
    v_add_u32 v4, s25, v4
    v_xor_b32 v5, 32, v4
    v_xor_b32 v6, 64, v4
    v_xor_b32 v7, 0x60, v4
    v_and_b32 v10, 15, v0
    v_lshlrev_b32 v11, 1, v10
    v_lshlrev_b32 v12, 4, v10
    v_bfe_u32 v13, v0, 4, 1
    v_lshl_add_u32 v12, v13, 3, v12
    v_lshlrev_b32 v10, 2, v10
    s_lshl_b32 s27, s5, 10
    s_lshl_b32 s7, s37, 9
    s_add_u32 s27, s27, s7
    s_add_u32 s28, s27, 27648
    s_barrier
    ds_read_b64_tr_b16 v[16:17], v8 offset:0
    ds_read_b64_tr_b16 v[18:19], v8 offset:512
    ds_read_b64_tr_b16 v[32:33], v4 offset:0
    ds_read_b64_tr_b16 v[34:35], v4 offset:512
    ds_read_b64_tr_b16 v[20:21], v9 offset:0
    ds_read_b64_tr_b16 v[22:23], v9 offset:512
    ds_read_b64_tr_b16 v[36:37], v5 offset:0
    ds_read_b64_tr_b16 v[38:39], v5 offset:512
    ds_read_b64_tr_b16 v[24:25], v8 offset:24576
    ds_read_b64_tr_b16 v[26:27], v8 offset:25088
    ds_read_b64_tr_b16 v[40:41], v6 offset:0
    ds_read_b64_tr_b16 v[42:43], v6 offset:512
    ds_read_b64_tr_b16 v[28:29], v9 offset:24576
    ds_read_b64_tr_b16 v[30:31], v9 offset:25088
    ds_read_b64_tr_b16 v[44:45], v7 offset:0
    ds_read_b64_tr_b16 v[46:47], v7 offset:512
    s_waitcnt lgkmcnt(0)
    s_barrier
    v_mfma_f32_16x16x32_bf16 v[104:107], v[16:19], v[32:35], 0
    ds_read_b64_tr_b16 v[48:49], v8 offset:4096
    ds_read_b64_tr_b16 v[50:51], v8 offset:4608
    v_mfma_f32_16x16x32_bf16 v[120:123], v[16:19], v[36:39], 0
    ds_read_b64_tr_b16 v[64:65], v4 offset:4096
    ds_read_b64_tr_b16 v[66:67], v4 offset:4608
    v_mfma_f32_16x16x32_bf16 v[136:139], v[16:19], v[40:43], 0
    ds_read_b64_tr_b16 v[52:53], v9 offset:4096
    ds_read_b64_tr_b16 v[54:55], v9 offset:4608
    v_mfma_f32_16x16x32_bf16 v[152:155], v[16:19], v[44:47], 0
    ds_read_b64_tr_b16 v[68:69], v5 offset:4096
    ds_read_b64_tr_b16 v[70:71], v5 offset:4608
    v_mfma_f32_16x16x32_bf16 v[108:111], v[20:23], v[32:35], 0
    ds_read_b64_tr_b16 v[56:57], v8 offset:28672
    v_mfma_f32_16x16x32_bf16 v[124:127], v[20:23], v[36:39], 0
    ds_read_b64_tr_b16 v[58:59], v8 offset:29184
    v_mfma_f32_16x16x32_bf16 v[140:143], v[20:23], v[40:43], 0
    ds_read_b64_tr_b16 v[72:73], v6 offset:4096
    v_mfma_f32_16x16x32_bf16 v[156:159], v[20:23], v[44:47], 0
    ds_read_b64_tr_b16 v[74:75], v6 offset:4608
    v_mfma_f32_16x16x32_bf16 v[112:115], v[24:27], v[32:35], 0
    ds_read_b64_tr_b16 v[60:61], v9 offset:28672
    v_mfma_f32_16x16x32_bf16 v[128:131], v[24:27], v[36:39], 0
    ds_read_b64_tr_b16 v[62:63], v9 offset:29184
    v_mfma_f32_16x16x32_bf16 v[144:147], v[24:27], v[40:43], 0
    ds_read_b64_tr_b16 v[76:77], v7 offset:4096
    v_mfma_f32_16x16x32_bf16 v[160:163], v[24:27], v[44:47], 0
    ds_read_b64_tr_b16 v[78:79], v7 offset:4608
    v_mfma_f32_16x16x32_bf16 v[116:119], v[28:31], v[32:35], 0
    v_mfma_f32_16x16x32_bf16 v[132:135], v[28:31], v[36:39], 0
    v_mfma_f32_16x16x32_bf16 v[148:151], v[28:31], v[40:43], 0
    v_mfma_f32_16x16x32_bf16 v[164:167], v[28:31], v[44:47], 0
    s_mov_b32 s31, 3
C_loop:
    s_waitcnt lgkmcnt(0)
    s_barrier
    v_mfma_f32_16x16x32_bf16 v[104:107], v[48:51], v[64:67], v[104:107]
    ds_read_b64_tr_b16 v[16:17], v8 offset:8192
    ds_read_b64_tr_b16 v[18:19], v8 offset:8704
    v_mfma_f32_16x16x32_bf16 v[120:123], v[48:51], v[68:71], v[120:123]
    ds_read_b64_tr_b16 v[32:33], v4 offset:8192
    ds_read_b64_tr_b16 v[34:35], v4 offset:8704
    v_mfma_f32_16x16x32_bf16 v[136:139], v[48:51], v[72:75], v[136:139]
    ds_read_b64_tr_b16 v[20:21], v9 offset:8192
    ds_read_b64_tr_b16 v[22:23], v9 offset:8704
    v_mfma_f32_16x16x32_bf16 v[152:155], v[48:51], v[76:79], v[152:155]
    ds_read_b64_tr_b16 v[36:37], v5 offset:8192
    ds_read_b64_tr_b16 v[38:39], v5 offset:8704
    v_mfma_f32_16x16x32_bf16 v[108:111], v[52:55], v[64:67], v[108:111]
    ds_read_b64_tr_b16 v[24:25], v8 offset:32768
    v_mfma_f32_16x16x32_bf16 v[124:127], v[52:55], v[68:71], v[124:127]
    ds_read_b64_tr_b16 v[26:27], v8 offset:33280
    v_mfma_f32_16x16x32_bf16 v[140:143], v[52:55], v[72:75], v[140:143]
    ds_read_b64_tr_b16 v[40:41], v6 offset:8192
    v_mfma_f32_16x16x32_bf16 v[156:159], v[52:55], v[76:79], v[156:159]
    ds_read_b64_tr_b16 v[42:43], v6 offset:8704
    v_mfma_f32_16x16x32_bf16 v[112:115], v[56:59], v[64:67], v[112:115]
    ds_read_b64_tr_b16 v[28:29], v9 offset:32768
    v_mfma_f32_16x16x32_bf16 v[128:131], v[56:59], v[68:71], v[128:131]
    ds_read_b64_tr_b16 v[30:31], v9 offset:33280
    v_mfma_f32_16x16x32_bf16 v[144:147], v[56:59], v[72:75], v[144:147]
    ds_read_b64_tr_b16 v[44:45], v7 offset:8192
    v_mfma_f32_16x16x32_bf16 v[160:163], v[56:59], v[76:79], v[160:163]
    ds_read_b64_tr_b16 v[46:47], v7 offset:8704
    v_mfma_f32_16x16x32_bf16 v[116:119], v[60:63], v[64:67], v[116:119]
    v_mfma_f32_16x16x32_bf16 v[132:135], v[60:63], v[68:71], v[132:135]
    v_mfma_f32_16x16x32_bf16 v[148:151], v[60:63], v[72:75], v[148:151]
    v_mfma_f32_16x16x32_bf16 v[164:167], v[60:63], v[76:79], v[164:167]
    s_waitcnt lgkmcnt(0)
    s_barrier
    v_mfma_f32_16x16x32_bf16 v[104:107], v[16:19], v[32:35], v[104:107]
    ds_read_b64_tr_b16 v[48:49], v8 offset:12288
    ds_read_b64_tr_b16 v[50:51], v8 offset:12800
    v_mfma_f32_16x16x32_bf16 v[120:123], v[16:19], v[36:39], v[120:123]
    ds_read_b64_tr_b16 v[64:65], v4 offset:12288
    ds_read_b64_tr_b16 v[66:67], v4 offset:12800
    v_mfma_f32_16x16x32_bf16 v[136:139], v[16:19], v[40:43], v[136:139]
    ds_read_b64_tr_b16 v[52:53], v9 offset:12288
    ds_read_b64_tr_b16 v[54:55], v9 offset:12800
    v_mfma_f32_16x16x32_bf16 v[152:155], v[16:19], v[44:47], v[152:155]
    ds_read_b64_tr_b16 v[68:69], v5 offset:12288
    ds_read_b64_tr_b16 v[70:71], v5 offset:12800
    v_mfma_f32_16x16x32_bf16 v[108:111], v[20:23], v[32:35], v[108:111]
    ds_read_b64_tr_b16 v[56:57], v8 offset:36864
    v_mfma_f32_16x16x32_bf16 v[124:127], v[20:23], v[36:39], v[124:127]
    ds_read_b64_tr_b16 v[58:59], v8 offset:37376
    v_mfma_f32_16x16x32_bf16 v[140:143], v[20:23], v[40:43], v[140:143]
    ds_read_b64_tr_b16 v[72:73], v6 offset:12288
    v_mfma_f32_16x16x32_bf16 v[156:159], v[20:23], v[44:47], v[156:159]
    ds_read_b64_tr_b16 v[74:75], v6 offset:12800
    buffer_load_dwordx2 v[80:81], v12, s[44:47], s27 offen offset:0
    v_mfma_f32_16x16x32_bf16 v[112:115], v[24:27], v[32:35], v[112:115]
    ds_read_b64_tr_b16 v[60:61], v9 offset:36864
    v_mfma_f32_16x16x32_bf16 v[128:131], v[24:27], v[36:39], v[128:131]
    ds_read_b64_tr_b16 v[62:63], v9 offset:37376
    v_mfma_f32_16x16x32_bf16 v[144:147], v[24:27], v[40:43], v[144:147]
    ds_read_b64_tr_b16 v[76:77], v7 offset:12288
    buffer_load_dwordx2 v[84:85], v12, s[44:47], s27 offen offset:256
    v_mfma_f32_16x16x32_bf16 v[160:163], v[24:27], v[44:47], v[160:163]
    ds_read_b64_tr_b16 v[78:79], v7 offset:12800
    v_mfma_f32_16x16x32_bf16 v[116:119], v[28:31], v[32:35], v[116:119]
    v_mfma_f32_16x16x32_bf16 v[132:135], v[28:31], v[36:39], v[132:135]
    buffer_load_dwordx2 v[88:89], v12, s[44:47], s28 offen offset:0
    v_mfma_f32_16x16x32_bf16 v[148:151], v[28:31], v[40:43], v[148:151]
    v_mfma_f32_16x16x32_bf16 v[164:167], v[28:31], v[44:47], v[164:167]
    buffer_load_dwordx2 v[92:93], v12, s[44:47], s28 offen offset:256
    s_waitcnt lgkmcnt(0)
    s_barrier
    v_mfma_f32_16x16x32_bf16 v[104:107], v[48:51], v[64:67], v[104:107]
    ds_read_b64_tr_b16 v[16:17], v8 offset:16384
    ds_read_b64_tr_b16 v[18:19], v8 offset:16896
    v_mfma_f32_16x16x32_bf16 v[120:123], v[48:51], v[68:71], v[120:123]
    ds_read_b64_tr_b16 v[32:33], v4 offset:16384
    ds_read_b64_tr_b16 v[34:35], v4 offset:16896
    v_mfma_f32_16x16x32_bf16 v[136:139], v[48:51], v[72:75], v[136:139]
    ds_read_b64_tr_b16 v[20:21], v9 offset:16384
    ds_read_b64_tr_b16 v[22:23], v9 offset:16896
    v_mfma_f32_16x16x32_bf16 v[152:155], v[48:51], v[76:79], v[152:155]
    ds_read_b64_tr_b16 v[36:37], v5 offset:16384
    ds_read_b64_tr_b16 v[38:39], v5 offset:16896
    v_mfma_f32_16x16x32_bf16 v[108:111], v[52:55], v[64:67], v[108:111]
    ds_read_b64_tr_b16 v[24:25], v8 offset:40960
    v_mfma_f32_16x16x32_bf16 v[124:127], v[52:55], v[68:71], v[124:127]
    ds_read_b64_tr_b16 v[26:27], v8 offset:41472
    v_mfma_f32_16x16x32_bf16 v[140:143], v[52:55], v[72:75], v[140:143]
    ds_read_b64_tr_b16 v[40:41], v6 offset:16384
    v_mfma_f32_16x16x32_bf16 v[156:159], v[52:55], v[76:79], v[156:159]
    ds_read_b64_tr_b16 v[42:43], v6 offset:16896
    buffer_load_dword v96, v10, s[32:35], s29 offen offset:0 sc1
    v_mfma_f32_16x16x32_bf16 v[112:115], v[56:59], v[64:67], v[112:115]
    ds_read_b64_tr_b16 v[28:29], v9 offset:40960
    v_mfma_f32_16x16x32_bf16 v[128:131], v[56:59], v[68:71], v[128:131]
    ds_read_b64_tr_b16 v[30:31], v9 offset:41472
    v_mfma_f32_16x16x32_bf16 v[144:147], v[56:59], v[72:75], v[144:147]
    ds_read_b64_tr_b16 v[44:45], v7 offset:16384
    buffer_load_dword v97, v10, s[32:35], s29 offen offset:64 sc1
    v_mfma_f32_16x16x32_bf16 v[160:163], v[56:59], v[76:79], v[160:163]
    ds_read_b64_tr_b16 v[46:47], v7 offset:16896
    v_mfma_f32_16x16x32_bf16 v[116:119], v[60:63], v[64:67], v[116:119]
    v_mfma_f32_16x16x32_bf16 v[132:135], v[60:63], v[68:71], v[132:135]
    buffer_load_dword v98, v10, s[32:35], s29 offen offset:128 sc1
    v_mfma_f32_16x16x32_bf16 v[148:151], v[60:63], v[72:75], v[148:151]
    v_mfma_f32_16x16x32_bf16 v[164:167], v[60:63], v[76:79], v[164:167]
    buffer_load_dword v99, v10, s[32:35], s29 offen offset:192 sc1
    s_waitcnt lgkmcnt(0)
    s_barrier
    v_mfma_f32_16x16x32_bf16 v[104:107], v[16:19], v[32:35], v[104:107]
    ds_read_b64_tr_b16 v[48:49], v8 offset:20480
    ds_read_b64_tr_b16 v[50:51], v8 offset:20992
    v_mfma_f32_16x16x32_bf16 v[120:123], v[16:19], v[36:39], v[120:123]
    ds_read_b64_tr_b16 v[64:65], v4 offset:20480
    ds_read_b64_tr_b16 v[66:67], v4 offset:20992
    v_mfma_f32_16x16x32_bf16 v[136:139], v[16:19], v[40:43], v[136:139]
    ds_read_b64_tr_b16 v[52:53], v9 offset:20480
    ds_read_b64_tr_b16 v[54:55], v9 offset:20992
    v_mfma_f32_16x16x32_bf16 v[152:155], v[16:19], v[44:47], v[152:155]
    ds_read_b64_tr_b16 v[68:69], v5 offset:20480
    ds_read_b64_tr_b16 v[70:71], v5 offset:20992
    v_mfma_f32_16x16x32_bf16 v[108:111], v[20:23], v[32:35], v[108:111]
    ds_read_b64_tr_b16 v[56:57], v8 offset:45056
    v_mfma_f32_16x16x32_bf16 v[124:127], v[20:23], v[36:39], v[124:127]
    ds_read_b64_tr_b16 v[58:59], v8 offset:45568
    v_mfma_f32_16x16x32_bf16 v[140:143], v[20:23], v[40:43], v[140:143]
    ds_read_b64_tr_b16 v[72:73], v6 offset:20480
    v_mfma_f32_16x16x32_bf16 v[156:159], v[20:23], v[44:47], v[156:159]
    ds_read_b64_tr_b16 v[74:75], v6 offset:20992
    v_mfma_f32_16x16x32_bf16 v[112:115], v[24:27], v[32:35], v[112:115]
    ds_read_b64_tr_b16 v[60:61], v9 offset:45056
    v_mfma_f32_16x16x32_bf16 v[128:131], v[24:27], v[36:39], v[128:131]
    ds_read_b64_tr_b16 v[62:63], v9 offset:45568
    v_mfma_f32_16x16x32_bf16 v[144:147], v[24:27], v[40:43], v[144:147]
    ds_read_b64_tr_b16 v[76:77], v7 offset:20480
    v_mfma_f32_16x16x32_bf16 v[160:163], v[24:27], v[44:47], v[160:163]
    ds_read_b64_tr_b16 v[78:79], v7 offset:20992
    v_mfma_f32_16x16x32_bf16 v[116:119], v[28:31], v[32:35], v[116:119]
    v_mfma_f32_16x16x32_bf16 v[132:135], v[28:31], v[36:39], v[132:135]
    v_mfma_f32_16x16x32_bf16 v[148:151], v[28:31], v[40:43], v[148:151]
    v_mfma_f32_16x16x32_bf16 v[164:167], v[28:31], v[44:47], v[164:167]
    s_waitcnt lgkmcnt(0)
    s_barrier
    v_mfma_f32_16x16x32_bf16 v[104:107], v[48:51], v[64:67], v[104:107]
    ds_read_b64_tr_b16 v[16:17], v8 offset:0
    ds_read_b64_tr_b16 v[18:19], v8 offset:512
    v_mfma_f32_16x16x32_bf16 v[120:123], v[48:51], v[68:71], v[120:123]
    ds_read_b64_tr_b16 v[32:33], v4 offset:0
    ds_read_b64_tr_b16 v[34:35], v4 offset:512
    v_mfma_f32_16x16x32_bf16 v[136:139], v[48:51], v[72:75], v[136:139]
    ds_read_b64_tr_b16 v[20:21], v9 offset:0
    ds_read_b64_tr_b16 v[22:23], v9 offset:512
    v_mfma_f32_16x16x32_bf16 v[152:155], v[48:51], v[76:79], v[152:155]
    ds_read_b64_tr_b16 v[36:37], v5 offset:0
    ds_read_b64_tr_b16 v[38:39], v5 offset:512
    v_mfma_f32_16x16x32_bf16 v[108:111], v[52:55], v[64:67], v[108:111]
    ds_read_b64_tr_b16 v[24:25], v8 offset:24576
    v_mfma_f32_16x16x32_bf16 v[124:127], v[52:55], v[68:71], v[124:127]
    ds_read_b64_tr_b16 v[26:27], v8 offset:25088
    v_mfma_f32_16x16x32_bf16 v[140:143], v[52:55], v[72:75], v[140:143]
    ds_read_b64_tr_b16 v[40:41], v6 offset:0
    v_mfma_f32_16x16x32_bf16 v[156:159], v[52:55], v[76:79], v[156:159]
    ds_read_b64_tr_b16 v[42:43], v6 offset:512
    v_mfma_f32_16x16x32_bf16 v[112:115], v[56:59], v[64:67], v[112:115]
    ds_read_b64_tr_b16 v[28:29], v9 offset:24576
    v_mfma_f32_16x16x32_bf16 v[128:131], v[56:59], v[68:71], v[128:131]
    ds_read_b64_tr_b16 v[30:31], v9 offset:25088
    v_mfma_f32_16x16x32_bf16 v[144:147], v[56:59], v[72:75], v[144:147]
    ds_read_b64_tr_b16 v[44:45], v7 offset:0
    v_mfma_f32_16x16x32_bf16 v[160:163], v[56:59], v[76:79], v[160:163]
    ds_read_b64_tr_b16 v[46:47], v7 offset:512
    v_mfma_f32_16x16x32_bf16 v[116:119], v[60:63], v[64:67], v[116:119]
    v_mfma_f32_16x16x32_bf16 v[132:135], v[60:63], v[68:71], v[132:135]
    v_mfma_f32_16x16x32_bf16 v[148:151], v[60:63], v[72:75], v[148:151]
    v_mfma_f32_16x16x32_bf16 v[164:167], v[60:63], v[76:79], v[164:167]
    s_waitcnt lgkmcnt(0)
    s_barrier
    v_mfma_f32_16x16x32_bf16 v[104:107], v[16:19], v[32:35], v[104:107]
    ds_read_b64_tr_b16 v[48:49], v8 offset:4096
    ds_read_b64_tr_b16 v[50:51], v8 offset:4608
    v_mfma_f32_16x16x32_bf16 v[120:123], v[16:19], v[36:39], v[120:123]
    ds_read_b64_tr_b16 v[64:65], v4 offset:4096
    ds_read_b64_tr_b16 v[66:67], v4 offset:4608
    v_mfma_f32_16x16x32_bf16 v[136:139], v[16:19], v[40:43], v[136:139]
    ds_read_b64_tr_b16 v[52:53], v9 offset:4096
    ds_read_b64_tr_b16 v[54:55], v9 offset:4608
    v_mfma_f32_16x16x32_bf16 v[152:155], v[16:19], v[44:47], v[152:155]
    ds_read_b64_tr_b16 v[68:69], v5 offset:4096
    ds_read_b64_tr_b16 v[70:71], v5 offset:4608
    v_mfma_f32_16x16x32_bf16 v[108:111], v[20:23], v[32:35], v[108:111]
    ds_read_b64_tr_b16 v[56:57], v8 offset:28672
    v_mfma_f32_16x16x32_bf16 v[124:127], v[20:23], v[36:39], v[124:127]
    ds_read_b64_tr_b16 v[58:59], v8 offset:29184
    v_mfma_f32_16x16x32_bf16 v[140:143], v[20:23], v[40:43], v[140:143]
    ds_read_b64_tr_b16 v[72:73], v6 offset:4096
    v_mfma_f32_16x16x32_bf16 v[156:159], v[20:23], v[44:47], v[156:159]
    ds_read_b64_tr_b16 v[74:75], v6 offset:4608
    v_mfma_f32_16x16x32_bf16 v[112:115], v[24:27], v[32:35], v[112:115]
    ds_read_b64_tr_b16 v[60:61], v9 offset:28672
    v_mfma_f32_16x16x32_bf16 v[128:131], v[24:27], v[36:39], v[128:131]
    ds_read_b64_tr_b16 v[62:63], v9 offset:29184
    v_mfma_f32_16x16x32_bf16 v[144:147], v[24:27], v[40:43], v[144:147]
    ds_read_b64_tr_b16 v[76:77], v7 offset:4096
    v_mfma_f32_16x16x32_bf16 v[160:163], v[24:27], v[44:47], v[160:163]
    ds_read_b64_tr_b16 v[78:79], v7 offset:4608
    v_mfma_f32_16x16x32_bf16 v[116:119], v[28:31], v[32:35], v[116:119]
    v_mfma_f32_16x16x32_bf16 v[132:135], v[28:31], v[36:39], v[132:135]
    v_mfma_f32_16x16x32_bf16 v[148:151], v[28:31], v[40:43], v[148:151]
    v_mfma_f32_16x16x32_bf16 v[164:167], v[28:31], v[44:47], v[164:167]
    s_sub_u32 s31, s31, 1
    s_cmp_lg_u32 s31, 0
    s_cbranch_scc1 C_loop
    s_waitcnt lgkmcnt(0)
    v_mfma_f32_16x16x32_bf16 v[104:107], v[48:51], v[64:67], v[104:107]
    v_mfma_f32_16x16x32_bf16 v[120:123], v[48:51], v[68:71], v[120:123]
    v_mfma_f32_16x16x32_bf16 v[136:139], v[48:51], v[72:75], v[136:139]
    v_mfma_f32_16x16x32_bf16 v[152:155], v[48:51], v[76:79], v[152:155]
    v_mfma_f32_16x16x32_bf16 v[108:111], v[52:55], v[64:67], v[108:111]
    v_mfma_f32_16x16x32_bf16 v[124:127], v[52:55], v[68:71], v[124:127]
    v_mfma_f32_16x16x32_bf16 v[140:143], v[52:55], v[72:75], v[140:143]
    v_mfma_f32_16x16x32_bf16 v[156:159], v[52:55], v[76:79], v[156:159]
    v_mfma_f32_16x16x32_bf16 v[112:115], v[56:59], v[64:67], v[112:115]
    v_mfma_f32_16x16x32_bf16 v[128:131], v[56:59], v[68:71], v[128:131]
    v_mfma_f32_16x16x32_bf16 v[144:147], v[56:59], v[72:75], v[144:147]
    v_mfma_f32_16x16x32_bf16 v[160:163], v[56:59], v[76:79], v[160:163]
    v_mfma_f32_16x16x32_bf16 v[116:119], v[60:63], v[64:67], v[116:119]
    v_mfma_f32_16x16x32_bf16 v[132:135], v[60:63], v[68:71], v[132:135]
    v_mfma_f32_16x16x32_bf16 v[148:151], v[60:63], v[72:75], v[148:151]
    v_mfma_f32_16x16x32_bf16 v[164:167], v[60:63], v[76:79], v[164:167]
C_j:
    s_movk_i32 s31, 0x2000
C_poll:
    s_waitcnt vmcnt(0)
    v_min_u32 v8, v96, v97
    v_min3_u32 v8, v8, v98, v99
    v_cmp_eq_u32 vcc, 0, v8
    s_cbranch_vccz C_got
    buffer_load_dword v96, v10, s[32:35], s29 offen offset:0 sc1
    buffer_load_dword v97, v10, s[32:35], s29 offen offset:64 sc1
    buffer_load_dword v98, v10, s[32:35], s29 offen offset:128 sc1
    buffer_load_dword v99, v10, s[32:35], s29 offen offset:192 sc1
    s_sub_u32 s31, s31, 1
    s_cmp_lg_u32 s31, 0
    s_cbranch_scc1 C_poll
    s_waitcnt vmcnt(0)
    s_movk_i32 s31, 640
    s_add_u32 s16, s8, 0x280000
    s_addc_u32 s17, s9, 0
    s_mov_b32 s18, 0x280000
    s_mov_b32 s19, 0x00020000
    v_mov_b32 v96, 0
    v_mov_b32 v97, 0
    v_mov_b32 v98, 0
    v_mov_b32 v99, 0
    v_mov_b32 v100, 0
    v_mov_b32 v101, 0
    v_mov_b32 v102, 0
    v_mov_b32 v103, 0
C_slow:
    buffer_load_ushort v16, v11, s[16:19], s30 offen offset:0
    buffer_load_ushort v17, v11, s[16:19], s30 offen offset:32
    buffer_load_ushort v18, v11, s[16:19], s30 offen offset:64
    buffer_load_ushort v19, v11, s[16:19], s30 offen offset:96
    s_add_u32 s30, s30, 4096
    s_waitcnt vmcnt(0)
    v_lshlrev_b32 v16, 16, v16
    v_add_f32 v96, v96, v16
    v_fmac_f32 v100, v16, v16
    v_lshlrev_b32 v17, 16, v17
    v_add_f32 v97, v97, v17
    v_fmac_f32 v101, v17, v17
    v_lshlrev_b32 v18, 16, v18
    v_add_f32 v98, v98, v18
    v_fmac_f32 v102, v18, v18
    v_lshlrev_b32 v19, 16, v19
    v_add_f32 v99, v99, v19
    v_fmac_f32 v103, v19, v19
    s_sub_u32 s31, s31, 1
    s_cmp_lg_u32 s31, 0
    s_cbranch_scc1 C_slow
    v_mul_f32 v96, 0x3acccccd, v96
    v_mul_f32 v100, 0x3acccccd, v100
    v_fma_f32 v100, -v96, v96, v100
    v_max_f32 v100, 0, v100
    v_cvt_pk_bf16_f32 v96, v96, v96
    v_lshlrev_b32 v96, 16, v96
    v_cvt_pk_bf16_f32 v100, v100, v100
    v_lshlrev_b32 v100, 16, v100
    v_add_f32 v100, 0x3727c5ac, v100
    v_cvt_pk_bf16_f32 v100, v100, v100
    v_lshlrev_b32 v100, 16, v100
    v_sqrt_f32 v100, v100
    s_nop 0
    v_cvt_pk_bf16_f32 v100, v100, v100
    v_lshlrev_b32 v100, 16, v100
    v_lshrrev_b32 v100, 16, v100
    v_or_b32 v96, v96, v100
    v_mul_f32 v97, 0x3acccccd, v97
    v_mul_f32 v101, 0x3acccccd, v101
    v_fma_f32 v101, -v97, v97, v101
    v_max_f32 v101, 0, v101
    v_cvt_pk_bf16_f32 v97, v97, v97
    v_lshlrev_b32 v97, 16, v97
    v_cvt_pk_bf16_f32 v101, v101, v101
    v_lshlrev_b32 v101, 16, v101
    v_add_f32 v101, 0x3727c5ac, v101
    v_cvt_pk_bf16_f32 v101, v101, v101
    v_lshlrev_b32 v101, 16, v101
    v_sqrt_f32 v101, v101
    s_nop 0
    v_cvt_pk_bf16_f32 v101, v101, v101
    v_lshlrev_b32 v101, 16, v101
    v_lshrrev_b32 v101, 16, v101
    v_or_b32 v97, v97, v101
    v_mul_f32 v98, 0x3acccccd, v98
    v_mul_f32 v102, 0x3acccccd, v102
    v_fma_f32 v102, -v98, v98, v102
    v_max_f32 v102, 0, v102
    v_cvt_pk_bf16_f32 v98, v98, v98
    v_lshlrev_b32 v98, 16, v98
    v_cvt_pk_bf16_f32 v102, v102, v102
    v_lshlrev_b32 v102, 16, v102
    v_add_f32 v102, 0x3727c5ac, v102
    v_cvt_pk_bf16_f32 v102, v102, v102
    v_lshlrev_b32 v102, 16, v102
    v_sqrt_f32 v102, v102
    s_nop 0
    v_cvt_pk_bf16_f32 v102, v102, v102
    v_lshlrev_b32 v102, 16, v102
    v_lshrrev_b32 v102, 16, v102
    v_or_b32 v98, v98, v102
    v_mul_f32 v99, 0x3acccccd, v99
    v_mul_f32 v103, 0x3acccccd, v103
    v_fma_f32 v103, -v99, v99, v103
    v_max_f32 v103, 0, v103
    v_cvt_pk_bf16_f32 v99, v99, v99
    v_lshlrev_b32 v99, 16, v99
    v_cvt_pk_bf16_f32 v103, v103, v103
    v_lshlrev_b32 v103, 16, v103
    v_add_f32 v103, 0x3727c5ac, v103
    v_cvt_pk_bf16_f32 v103, v103, v103
    v_lshlrev_b32 v103, 16, v103
    v_sqrt_f32 v103, v103
    s_nop 0
    v_cvt_pk_bf16_f32 v103, v103, v103
    v_lshlrev_b32 v103, 16, v103
    v_lshrrev_b32 v103, 16, v103
    v_or_b32 v99, v99, v103
C_got:
    v_cmp_gt_u32 vcc, 32, v0
    v_lshlrev_b32 v100, 16, v96
    v_and_b32 v96, 0xffff0000, v96
    v_cvt_pk_bf16_f32 v16, -v96, -v96
    v_cvt_pk_bf16_f32 v17, v100, v100
    v_rcp_f32 v96, v100
    v_cndmask_b32 v16, 0, v16, vcc
    v_cndmask_b32 v17, 0, v17, vcc
    v_lshlrev_b32 v101, 16, v97
    v_and_b32 v97, 0xffff0000, v97
    v_cvt_pk_bf16_f32 v20, -v97, -v97
    v_cvt_pk_bf16_f32 v21, v101, v101
    v_rcp_f32 v97, v101
    v_cndmask_b32 v20, 0, v20, vcc
    v_cndmask_b32 v21, 0, v21, vcc
    v_lshlrev_b32 v102, 16, v98
    v_and_b32 v98, 0xffff0000, v98
    v_cvt_pk_bf16_f32 v24, -v98, -v98
    v_cvt_pk_bf16_f32 v25, v102, v102
    v_rcp_f32 v98, v102
    v_cndmask_b32 v24, 0, v24, vcc
    v_cndmask_b32 v25, 0, v25, vcc
    v_lshlrev_b32 v103, 16, v99
    v_and_b32 v99, 0xffff0000, v99
    v_cvt_pk_bf16_f32 v28, -v99, -v99
    v_cvt_pk_bf16_f32 v29, v103, v103
    v_rcp_f32 v99, v103
    v_cndmask_b32 v28, 0, v28, vcc
    v_cndmask_b32 v29, 0, v29, vcc
    s_nop 1
    v_mfma_f32_16x16x16_bf16 v[104:107], v[80:81], v[16:17], v[104:107]
    v_mfma_f32_16x16x16_bf16 v[108:111], v[84:85], v[16:17], v[108:111]
    v_mfma_f32_16x16x16_bf16 v[112:115], v[88:89], v[16:17], v[112:115]
    v_mfma_f32_16x16x16_bf16 v[116:119], v[92:93], v[16:17], v[116:119]
    v_mfma_f32_16x16x16_bf16 v[120:123], v[80:81], v[20:21], v[120:123]
    v_mfma_f32_16x16x16_bf16 v[124:127], v[84:85], v[20:21], v[124:127]
    v_mfma_f32_16x16x16_bf16 v[128:131], v[88:89], v[20:21], v[128:131]
    v_mfma_f32_16x16x16_bf16 v[132:135], v[92:93], v[20:21], v[132:135]
    v_mfma_f32_16x16x16_bf16 v[136:139], v[80:81], v[24:25], v[136:139]
    v_mfma_f32_16x16x16_bf16 v[140:143], v[84:85], v[24:25], v[140:143]
    v_mfma_f32_16x16x16_bf16 v[144:147], v[88:89], v[24:25], v[144:147]
    v_mfma_f32_16x16x16_bf16 v[148:151], v[92:93], v[24:25], v[148:151]
    v_mfma_f32_16x16x16_bf16 v[152:155], v[80:81], v[28:29], v[152:155]
    v_mfma_f32_16x16x16_bf16 v[156:159], v[84:85], v[28:29], v[156:159]
    v_mfma_f32_16x16x16_bf16 v[160:163], v[88:89], v[28:29], v[160:163]
    v_mfma_f32_16x16x16_bf16 v[164:167], v[92:93], v[28:29], v[164:167]
    v_lshlrev_b32 v14, 4, v0
    s_lshl_b32 s6, s4, 4
    s_lshl_b32 s7, s36, 2
    s_add_u32 s6, s6, s7
    s_mul_i32 s6, s6, 55296
    s_lshl_b32 s7, s5, 11
    s_add_u32 s6, s6, s7
    s_lshl_b32 s7, s37, 10
    s_add_u32 s6, s6, s7
    v_mul_f32 v96, 0x3fb8aa3b, v96
    v_mul_f32 v100, v100, v100
    v_mul_f32 v97, 0x3fb8aa3b, v97
    v_mul_f32 v101, v101, v101
    v_mul_f32 v98, 0x3fb8aa3b, v98
    v_mul_f32 v102, v102, v102
    v_mul_f32 v99, 0x3fb8aa3b, v99
    v_mul_f32 v103, v103, v103
    v_mul_f32 v32, v104, v96
    v_mul_f32 v33, v105, v96
    v_mul_f32 v34, v106, v96
    v_mul_f32 v35, v107, v96
    v_mul_f32 v36, v108, v96
    v_mul_f32 v37, v109, v96
    v_mul_f32 v38, v110, v96
    v_mul_f32 v39, v111, v96
    v_exp_f32 v32, -v32
    v_mul_f32 v104, v104, v112
    v_exp_f32 v33, -v33
    v_mul_f32 v105, v105, v113
    v_exp_f32 v34, -v34
    v_mul_f32 v106, v106, v114
    v_exp_f32 v35, -v35
    v_mul_f32 v107, v107, v115
    v_exp_f32 v36, -v36
    v_mul_f32 v108, v108, v116
    v_exp_f32 v37, -v37
    v_mul_f32 v109, v109, v117
    v_exp_f32 v38, -v38
    v_mul_f32 v110, v110, v118
    v_exp_f32 v39, -v39
    v_mul_f32 v111, v111, v119
    v_fma_f32 v32, v32, v100, v100
    v_fma_f32 v33, v33, v100, v100
    v_fma_f32 v34, v34, v100, v100
    v_fma_f32 v35, v35, v100, v100
    v_fma_f32 v36, v36, v100, v100
    v_fma_f32 v37, v37, v100, v100
    v_fma_f32 v38, v38, v100, v100
    v_fma_f32 v39, v39, v100, v100
    v_rcp_f32 v32, v32
    v_rcp_f32 v33, v33
    v_rcp_f32 v34, v34
    v_rcp_f32 v35, v35
    v_rcp_f32 v36, v36
    v_rcp_f32 v37, v37
    v_rcp_f32 v38, v38
    v_rcp_f32 v39, v39
    v_mul_f32 v104, v104, v32
    v_mul_f32 v105, v105, v33
    v_mul_f32 v106, v106, v34
    v_mul_f32 v107, v107, v35
    v_mul_f32 v108, v108, v36
    v_mul_f32 v109, v109, v37
    v_mul_f32 v110, v110, v38
    v_mul_f32 v111, v111, v39
    v_cvt_pk_bf16_f32 v116, v104, v105
    v_cvt_pk_bf16_f32 v117, v106, v107
    v_cvt_pk_bf16_f32 v118, v108, v109
    v_cvt_pk_bf16_f32 v119, v110, v111
    buffer_store_dwordx4 v[116:119], v14, s[20:23], s6 offen sc0 sc1
    s_add_u32 s6, s6, 55296
    v_mul_f32 v40, v120, v97
    v_mul_f32 v41, v121, v97
    v_mul_f32 v42, v122, v97
    v_mul_f32 v43, v123, v97
    v_mul_f32 v44, v124, v97
    v_mul_f32 v45, v125, v97
    v_mul_f32 v46, v126, v97
    v_mul_f32 v47, v127, v97
    v_exp_f32 v40, -v40
    v_mul_f32 v120, v120, v128
    v_exp_f32 v41, -v41
    v_mul_f32 v121, v121, v129
    v_exp_f32 v42, -v42
    v_mul_f32 v122, v122, v130
    v_exp_f32 v43, -v43
    v_mul_f32 v123, v123, v131
    v_exp_f32 v44, -v44
    v_mul_f32 v124, v124, v132
    v_exp_f32 v45, -v45
    v_mul_f32 v125, v125, v133
    v_exp_f32 v46, -v46
    v_mul_f32 v126, v126, v134
    v_exp_f32 v47, -v47
    v_mul_f32 v127, v127, v135
    v_fma_f32 v40, v40, v101, v101
    v_fma_f32 v41, v41, v101, v101
    v_fma_f32 v42, v42, v101, v101
    v_fma_f32 v43, v43, v101, v101
    v_fma_f32 v44, v44, v101, v101
    v_fma_f32 v45, v45, v101, v101
    v_fma_f32 v46, v46, v101, v101
    v_fma_f32 v47, v47, v101, v101
    v_rcp_f32 v40, v40
    v_rcp_f32 v41, v41
    v_rcp_f32 v42, v42
    v_rcp_f32 v43, v43
    v_rcp_f32 v44, v44
    v_rcp_f32 v45, v45
    v_rcp_f32 v46, v46
    v_rcp_f32 v47, v47
    v_mul_f32 v120, v120, v40
    v_mul_f32 v121, v121, v41
    v_mul_f32 v122, v122, v42
    v_mul_f32 v123, v123, v43
    v_mul_f32 v124, v124, v44
    v_mul_f32 v125, v125, v45
    v_mul_f32 v126, v126, v46
    v_mul_f32 v127, v127, v47
    v_cvt_pk_bf16_f32 v132, v120, v121
    v_cvt_pk_bf16_f32 v133, v122, v123
    v_cvt_pk_bf16_f32 v134, v124, v125
    v_cvt_pk_bf16_f32 v135, v126, v127
    buffer_store_dwordx4 v[132:135], v14, s[20:23], s6 offen sc0 sc1
    s_add_u32 s6, s6, 55296
    v_mul_f32 v32, v136, v98
    v_mul_f32 v33, v137, v98
    v_mul_f32 v34, v138, v98
    v_mul_f32 v35, v139, v98
    v_mul_f32 v36, v140, v98
    v_mul_f32 v37, v141, v98
    v_mul_f32 v38, v142, v98
    v_mul_f32 v39, v143, v98
    v_exp_f32 v32, -v32
    v_mul_f32 v136, v136, v144
    v_exp_f32 v33, -v33
    v_mul_f32 v137, v137, v145
    v_exp_f32 v34, -v34
    v_mul_f32 v138, v138, v146
    v_exp_f32 v35, -v35
    v_mul_f32 v139, v139, v147
    v_exp_f32 v36, -v36
    v_mul_f32 v140, v140, v148
    v_exp_f32 v37, -v37
    v_mul_f32 v141, v141, v149
    v_exp_f32 v38, -v38
    v_mul_f32 v142, v142, v150
    v_exp_f32 v39, -v39
    v_mul_f32 v143, v143, v151
    v_fma_f32 v32, v32, v102, v102
    v_fma_f32 v33, v33, v102, v102
    v_fma_f32 v34, v34, v102, v102
    v_fma_f32 v35, v35, v102, v102
    v_fma_f32 v36, v36, v102, v102
    v_fma_f32 v37, v37, v102, v102
    v_fma_f32 v38, v38, v102, v102
    v_fma_f32 v39, v39, v102, v102
    v_rcp_f32 v32, v32
    v_rcp_f32 v33, v33
    v_rcp_f32 v34, v34
    v_rcp_f32 v35, v35
    v_rcp_f32 v36, v36
    v_rcp_f32 v37, v37
    v_rcp_f32 v38, v38
    v_rcp_f32 v39, v39
    v_mul_f32 v136, v136, v32
    v_mul_f32 v137, v137, v33
    v_mul_f32 v138, v138, v34
    v_mul_f32 v139, v139, v35
    v_mul_f32 v140, v140, v36
    v_mul_f32 v141, v141, v37
    v_mul_f32 v142, v142, v38
    v_mul_f32 v143, v143, v39
    v_cvt_pk_bf16_f32 v148, v136, v137
    v_cvt_pk_bf16_f32 v149, v138, v139
    v_cvt_pk_bf16_f32 v150, v140, v141
    v_cvt_pk_bf16_f32 v151, v142, v143
    buffer_store_dwordx4 v[148:151], v14, s[20:23], s6 offen sc0 sc1
    s_add_u32 s6, s6, 55296
    v_mul_f32 v40, v152, v99
    v_mul_f32 v41, v153, v99
    v_mul_f32 v42, v154, v99
    v_mul_f32 v43, v155, v99
    v_mul_f32 v44, v156, v99
    v_mul_f32 v45, v157, v99
    v_mul_f32 v46, v158, v99
    v_mul_f32 v47, v159, v99
    v_exp_f32 v40, -v40
    v_mul_f32 v152, v152, v160
    v_exp_f32 v41, -v41
    v_mul_f32 v153, v153, v161
    v_exp_f32 v42, -v42
    v_mul_f32 v154, v154, v162
    v_exp_f32 v43, -v43
    v_mul_f32 v155, v155, v163
    v_exp_f32 v44, -v44
    v_mul_f32 v156, v156, v164
    v_exp_f32 v45, -v45
    v_mul_f32 v157, v157, v165
    v_exp_f32 v46, -v46
    v_mul_f32 v158, v158, v166
    v_exp_f32 v47, -v47
    v_mul_f32 v159, v159, v167
    v_fma_f32 v40, v40, v103, v103
    v_fma_f32 v41, v41, v103, v103
    v_fma_f32 v42, v42, v103, v103
    v_fma_f32 v43, v43, v103, v103
    v_fma_f32 v44, v44, v103, v103
    v_fma_f32 v45, v45, v103, v103
    v_fma_f32 v46, v46, v103, v103
    v_fma_f32 v47, v47, v103, v103
    v_rcp_f32 v40, v40
    v_rcp_f32 v41, v41
    v_rcp_f32 v42, v42
    v_rcp_f32 v43, v43
    v_rcp_f32 v44, v44
    v_rcp_f32 v45, v45
    v_rcp_f32 v46, v46
    v_rcp_f32 v47, v47
    v_mul_f32 v152, v152, v40
    v_mul_f32 v153, v153, v41
    v_mul_f32 v154, v154, v42
    v_mul_f32 v155, v155, v43
    v_mul_f32 v156, v156, v44
    v_mul_f32 v157, v157, v45
    v_mul_f32 v158, v158, v46
    v_mul_f32 v159, v159, v47
    v_cvt_pk_bf16_f32 v164, v152, v153
    v_cvt_pk_bf16_f32 v165, v154, v155
    v_cvt_pk_bf16_f32 v166, v156, v157
    v_cvt_pk_bf16_f32 v167, v158, v159
    buffer_store_dwordx4 v[164:167], v14, s[20:23], s6 offen sc0 sc1
    s_add_u32 s6, s6, 55296
    s_endpgm
C_st:
    s_load_dwordx2 s[8:9], s[0:1], 120
    s_load_dwordx2 s[10:11], s[0:1], 80
    v_lshrrev_b32 v1, 3, v0
    v_and_b32 v2, 7, v0
    v_lshlrev_b32 v3, 12, v1
    v_lshl_add_u32 v3, v2, 4, v3
    s_lshl_b32 s4, s2, 7
    v_lshrrev_b32 v7, 6, v0
    s_nop 0
    v_readfirstlane_b32 s3, v7
    s_cmp_ge_u32 s3, 8
    s_cbranch_scc1 C_end
    s_mov_b32 s6, 0xffff0000
    s_waitcnt lgkmcnt(0)
    s_add_u32 s16, s8, 0x280000
    s_addc_u32 s17, s9, 0
    s_mov_b32 s18, 0x280000
    s_mov_b32 s19, 0x00020000
    s_add_u32 s32, s8, 0x788000
    s_addc_u32 s33, s9, 0
    s_mov_b32 s34, 0x2000
    s_mov_b32 s35, 0x00020000
    s_mov_b32 s12, s10
    s_mov_b32 s13, s11
    s_mov_b32 s14, 0x21c000
    s_mov_b32 s15, 0x00020000
    s_add_u32 s24, s8, 0xd00000
    s_addc_u32 s25, s9, 0
    s_mov_b32 s26, 0x21c000
    s_mov_b32 s27, 0x00020000
    s_add_u32 s20, s8, 0x790000
    s_addc_u32 s21, s9, 0
    s_mov_b32 s22, 0xf000
    s_mov_b32 s23, 0x00020000
    buffer_load_dwordx4 v[32:35], v3, s[16:19], s4 offen
    s_add_u32 s4, s4, 0x40000
    buffer_load_dwordx4 v[36:39], v3, s[16:19], s4 offen
    s_add_u32 s4, s4, 0x40000
    buffer_load_dwordx4 v[40:43], v3, s[16:19], s4 offen
    s_add_u32 s4, s4, 0x40000
    buffer_load_dwordx4 v[44:47], v3, s[16:19], s4 offen
    s_add_u32 s4, s4, 0x40000
    buffer_load_dwordx4 v[48:51], v3, s[16:19], s4 offen
    s_add_u32 s4, s4, 0x40000
    buffer_load_dwordx4 v[52:55], v3, s[16:19], s4 offen
    s_add_u32 s4, s4, 0x40000
    buffer_load_dwordx4 v[56:59], v3, s[16:19], s4 offen
    s_add_u32 s4, s4, 0x40000
    buffer_load_dwordx4 v[60:63], v3, s[16:19], s4 offen
    s_add_u32 s4, s4, 0x40000
    buffer_load_dwordx4 v[64:67], v3, s[16:19], s4 offen
    s_add_u32 s4, s4, 0x40000
    buffer_load_dwordx4 v[68:71], v3, s[16:19], s4 offen
    s_add_u32 s4, s4, 0x40000
    v_lshlrev_b32 v75, 4, v0
    s_mul_i32 s7, s2, 40960
    s_lshl_b32 s5, s3, 10
    s_add_u32 m0, s5, 40960
    v_and_b32 v72, 63, v0
    buffer_load_dwordx4 v75, s[12:15], s7 offen lds
    s_add_u32 m0, m0, 8192
    s_add_u32 s7, s7, 8192
    buffer_load_dwordx4 v75, s[12:15], s7 offen lds
    s_add_u32 m0, m0, 8192
    s_add_u32 s7, s7, 8192
    buffer_load_dwordx4 v75, s[12:15], s7 offen lds
    s_add_u32 m0, m0, 8192
    s_add_u32 s7, s7, 8192
    buffer_load_dwordx4 v75, s[12:15], s7 offen lds
    s_add_u32 m0, m0, 8192
    s_add_u32 s7, s7, 8192
    buffer_load_dwordx4 v75, s[12:15], s7 offen lds
    s_add_u32 m0, m0, 8192
    s_add_u32 s7, s7, 1277952
    buffer_load_dwordx4 v75, s[12:15], s7 offen lds
    s_add_u32 m0, m0, 8192
    s_add_u32 s7, s7, 8192
    buffer_load_dwordx4 v75, s[12:15], s7 offen lds
    s_add_u32 m0, m0, 8192
    s_add_u32 s7, s7, 8192
    buffer_load_dwordx4 v75, s[12:15], s7 offen lds
    s_add_u32 m0, m0, 8192
    s_add_u32 s7, s7, 8192
    buffer_load_dwordx4 v75, s[12:15], s7 offen lds
    s_add_u32 m0, m0, 8192
    s_add_u32 s7, s7, 8192
    buffer_load_dwordx4 v75, s[12:15], s7 offen lds
    s_add_u32 m0, m0, 8192
    s_add_u32 s7, s7, 8192
    v_lshrrev_b32 v73, 4, v72
    v_bfe_u32 v74, v72, 2, 2
    v_and_b32 v76, 3, v72
    v_mul_u32_u24 v77, 80, v74
    v_lshl_add_u32 v77, v76, 2, v77
    v_mul_u32_u24 v78, 15360, v73
    v_add_u32 v77, v77, v78
    s_mul_i32 s5, s3, 320
    s_add_u32 s5, s5, 12800
    buffer_load_dword v80, v77, s[20:23], s5 offen offset:0
    buffer_load_dword v81, v77, s[20:23], s5 offen offset:16
    buffer_load_dword v82, v77, s[20:23], s5 offen offset:32
    buffer_load_dword v83, v77, s[20:23], s5 offen offset:48
    buffer_load_dword v84, v77, s[20:23], s5 offen offset:64
    v_lshl_add_u32 v74, v73, 2, v74
    v_mul_u32_u24 v74, 1280, v74
    v_mul_u32_u24 v76, 40, v76
    v_mul_u32_u24 v78, 160, v7
    v_add3_u32 v74, v74, v76, v78
    v_add_u32 v74, 40960, v74
    v_lshlrev_b32 v75, 4, v72
    v_mov_b32 v8, 0
    v_mov_b32 v9, 0
    v_mov_b32 v10, 0
    v_mov_b32 v11, 0
    v_mov_b32 v12, 0
    v_mov_b32 v13, 0
    v_mov_b32 v14, 0
    v_mov_b32 v15, 0
    v_mov_b32 v16, 0
    v_mov_b32 v17, 0
    v_mov_b32 v18, 0
    v_mov_b32 v19, 0
    v_mov_b32 v20, 0
    v_mov_b32 v21, 0
    v_mov_b32 v22, 0
    v_mov_b32 v23, 0
    s_waitcnt vmcnt(24)
    v_lshlrev_b32 v24, 16, v32
    v_and_b32 v25, s6, v32
    v_lshlrev_b32 v26, 16, v33
    v_and_b32 v27, s6, v33
    v_lshlrev_b32 v28, 16, v34
    v_and_b32 v29, s6, v34
    v_lshlrev_b32 v30, 16, v35
    v_and_b32 v31, s6, v35
    v_pk_add_f32 v[8:9], v[8:9], v[24:25]
    v_pk_fma_f32 v[16:17], v[24:25], v[24:25], v[16:17]
    v_pk_add_f32 v[10:11], v[10:11], v[26:27]
    v_pk_fma_f32 v[18:19], v[26:27], v[26:27], v[18:19]
    v_pk_add_f32 v[12:13], v[12:13], v[28:29]
    v_pk_fma_f32 v[20:21], v[28:29], v[28:29], v[20:21]
    v_pk_add_f32 v[14:15], v[14:15], v[30:31]
    v_pk_fma_f32 v[22:23], v[30:31], v[30:31], v[22:23]
    s_waitcnt vmcnt(23)
    v_lshlrev_b32 v24, 16, v36
    v_and_b32 v25, s6, v36
    v_lshlrev_b32 v26, 16, v37
    v_and_b32 v27, s6, v37
    v_lshlrev_b32 v28, 16, v38
    v_and_b32 v29, s6, v38
    v_lshlrev_b32 v30, 16, v39
    v_and_b32 v31, s6, v39
    v_pk_add_f32 v[8:9], v[8:9], v[24:25]
    v_pk_fma_f32 v[16:17], v[24:25], v[24:25], v[16:17]
    v_pk_add_f32 v[10:11], v[10:11], v[26:27]
    v_pk_fma_f32 v[18:19], v[26:27], v[26:27], v[18:19]
    v_pk_add_f32 v[12:13], v[12:13], v[28:29]
    v_pk_fma_f32 v[20:21], v[28:29], v[28:29], v[20:21]
    v_pk_add_f32 v[14:15], v[14:15], v[30:31]
    v_pk_fma_f32 v[22:23], v[30:31], v[30:31], v[22:23]
    s_waitcnt vmcnt(22)
    v_lshlrev_b32 v24, 16, v40
    v_and_b32 v25, s6, v40
    v_lshlrev_b32 v26, 16, v41
    v_and_b32 v27, s6, v41
    v_lshlrev_b32 v28, 16, v42
    v_and_b32 v29, s6, v42
    v_lshlrev_b32 v30, 16, v43
    v_and_b32 v31, s6, v43
    v_pk_add_f32 v[8:9], v[8:9], v[24:25]
    v_pk_fma_f32 v[16:17], v[24:25], v[24:25], v[16:17]
    v_pk_add_f32 v[10:11], v[10:11], v[26:27]
    v_pk_fma_f32 v[18:19], v[26:27], v[26:27], v[18:19]
    v_pk_add_f32 v[12:13], v[12:13], v[28:29]
    v_pk_fma_f32 v[20:21], v[28:29], v[28:29], v[20:21]
    v_pk_add_f32 v[14:15], v[14:15], v[30:31]
    v_pk_fma_f32 v[22:23], v[30:31], v[30:31], v[22:23]
    s_waitcnt vmcnt(21)
    v_lshlrev_b32 v24, 16, v44
    v_and_b32 v25, s6, v44
    v_lshlrev_b32 v26, 16, v45
    v_and_b32 v27, s6, v45
    v_lshlrev_b32 v28, 16, v46
    v_and_b32 v29, s6, v46
    v_lshlrev_b32 v30, 16, v47
    v_and_b32 v31, s6, v47
    v_pk_add_f32 v[8:9], v[8:9], v[24:25]
    v_pk_fma_f32 v[16:17], v[24:25], v[24:25], v[16:17]
    v_pk_add_f32 v[10:11], v[10:11], v[26:27]
    v_pk_fma_f32 v[18:19], v[26:27], v[26:27], v[18:19]
    v_pk_add_f32 v[12:13], v[12:13], v[28:29]
    v_pk_fma_f32 v[20:21], v[28:29], v[28:29], v[20:21]
    v_pk_add_f32 v[14:15], v[14:15], v[30:31]
    v_pk_fma_f32 v[22:23], v[30:31], v[30:31], v[22:23]
    s_waitcnt vmcnt(20)
    v_lshlrev_b32 v24, 16, v48
    v_and_b32 v25, s6, v48
    v_lshlrev_b32 v26, 16, v49
    v_and_b32 v27, s6, v49
    v_lshlrev_b32 v28, 16, v50
    v_and_b32 v29, s6, v50
    v_lshlrev_b32 v30, 16, v51
    v_and_b32 v31, s6, v51
    v_pk_add_f32 v[8:9], v[8:9], v[24:25]
    v_pk_fma_f32 v[16:17], v[24:25], v[24:25], v[16:17]
    v_pk_add_f32 v[10:11], v[10:11], v[26:27]
    v_pk_fma_f32 v[18:19], v[26:27], v[26:27], v[18:19]
    v_pk_add_f32 v[12:13], v[12:13], v[28:29]
    v_pk_fma_f32 v[20:21], v[28:29], v[28:29], v[20:21]
    v_pk_add_f32 v[14:15], v[14:15], v[30:31]
    v_pk_fma_f32 v[22:23], v[30:31], v[30:31], v[22:23]
    s_waitcnt vmcnt(19)
    v_lshlrev_b32 v24, 16, v52
    v_and_b32 v25, s6, v52
    v_lshlrev_b32 v26, 16, v53
    v_and_b32 v27, s6, v53
    v_lshlrev_b32 v28, 16, v54
    v_and_b32 v29, s6, v54
    v_lshlrev_b32 v30, 16, v55
    v_and_b32 v31, s6, v55
    v_pk_add_f32 v[8:9], v[8:9], v[24:25]
    v_pk_fma_f32 v[16:17], v[24:25], v[24:25], v[16:17]
    v_pk_add_f32 v[10:11], v[10:11], v[26:27]
    v_pk_fma_f32 v[18:19], v[26:27], v[26:27], v[18:19]
    v_pk_add_f32 v[12:13], v[12:13], v[28:29]
    v_pk_fma_f32 v[20:21], v[28:29], v[28:29], v[20:21]
    v_pk_add_f32 v[14:15], v[14:15], v[30:31]
    v_pk_fma_f32 v[22:23], v[30:31], v[30:31], v[22:23]
    s_waitcnt vmcnt(18)
    v_lshlrev_b32 v24, 16, v56
    v_and_b32 v25, s6, v56
    v_lshlrev_b32 v26, 16, v57
    v_and_b32 v27, s6, v57
    v_lshlrev_b32 v28, 16, v58
    v_and_b32 v29, s6, v58
    v_lshlrev_b32 v30, 16, v59
    v_and_b32 v31, s6, v59
    v_pk_add_f32 v[8:9], v[8:9], v[24:25]
    v_pk_fma_f32 v[16:17], v[24:25], v[24:25], v[16:17]
    v_pk_add_f32 v[10:11], v[10:11], v[26:27]
    v_pk_fma_f32 v[18:19], v[26:27], v[26:27], v[18:19]
    v_pk_add_f32 v[12:13], v[12:13], v[28:29]
    v_pk_fma_f32 v[20:21], v[28:29], v[28:29], v[20:21]
    v_pk_add_f32 v[14:15], v[14:15], v[30:31]
    v_pk_fma_f32 v[22:23], v[30:31], v[30:31], v[22:23]
    s_waitcnt vmcnt(17)
    v_lshlrev_b32 v24, 16, v60
    v_and_b32 v25, s6, v60
    v_lshlrev_b32 v26, 16, v61
    v_and_b32 v27, s6, v61
    v_lshlrev_b32 v28, 16, v62
    v_and_b32 v29, s6, v62
    v_lshlrev_b32 v30, 16, v63
    v_and_b32 v31, s6, v63
    v_pk_add_f32 v[8:9], v[8:9], v[24:25]
    v_pk_fma_f32 v[16:17], v[24:25], v[24:25], v[16:17]
    v_pk_add_f32 v[10:11], v[10:11], v[26:27]
    v_pk_fma_f32 v[18:19], v[26:27], v[26:27], v[18:19]
    v_pk_add_f32 v[12:13], v[12:13], v[28:29]
    v_pk_fma_f32 v[20:21], v[28:29], v[28:29], v[20:21]
    v_pk_add_f32 v[14:15], v[14:15], v[30:31]
    v_pk_fma_f32 v[22:23], v[30:31], v[30:31], v[22:23]
    s_waitcnt vmcnt(16)
    v_lshlrev_b32 v24, 16, v64
    v_and_b32 v25, s6, v64
    v_lshlrev_b32 v26, 16, v65
    v_and_b32 v27, s6, v65
    v_lshlrev_b32 v28, 16, v66
    v_and_b32 v29, s6, v66
    v_lshlrev_b32 v30, 16, v67
    v_and_b32 v31, s6, v67
    v_pk_add_f32 v[8:9], v[8:9], v[24:25]
    v_pk_fma_f32 v[16:17], v[24:25], v[24:25], v[16:17]
    v_pk_add_f32 v[10:11], v[10:11], v[26:27]
    v_pk_fma_f32 v[18:19], v[26:27], v[26:27], v[18:19]
    v_pk_add_f32 v[12:13], v[12:13], v[28:29]
    v_pk_fma_f32 v[20:21], v[28:29], v[28:29], v[20:21]
    v_pk_add_f32 v[14:15], v[14:15], v[30:31]
    v_pk_fma_f32 v[22:23], v[30:31], v[30:31], v[22:23]
    s_waitcnt vmcnt(15)
    v_lshlrev_b32 v24, 16, v68
    v_and_b32 v25, s6, v68
    v_lshlrev_b32 v26, 16, v69
    v_and_b32 v27, s6, v69
    v_lshlrev_b32 v28, 16, v70
    v_and_b32 v29, s6, v70
    v_lshlrev_b32 v30, 16, v71
    v_and_b32 v31, s6, v71
    v_pk_add_f32 v[8:9], v[8:9], v[24:25]
    v_pk_fma_f32 v[16:17], v[24:25], v[24:25], v[16:17]
    v_pk_add_f32 v[10:11], v[10:11], v[26:27]
    v_pk_fma_f32 v[18:19], v[26:27], v[26:27], v[18:19]
    v_pk_add_f32 v[12:13], v[12:13], v[28:29]
    v_pk_fma_f32 v[20:21], v[28:29], v[28:29], v[20:21]
    v_pk_add_f32 v[14:15], v[14:15], v[30:31]
    v_pk_fma_f32 v[22:23], v[30:31], v[30:31], v[22:23]
    v_lshlrev_b32 v4, 9, v1
    v_lshl_add_u32 v4, v2, 5, v4
    ds_write_b128 v4, v[8:11]
    ds_write_b128 v4, v[12:15] offset:16
    ds_write_b128 v4, v[16:19] offset:256
    ds_write_b128 v4, v[20:23] offset:272
    v_and_b32 v6, 63, v0
    v_lshlrev_b32 v6, 2, v6
    v_lshl_add_u32 v5, v7, 12, v6
    s_waitcnt lgkmcnt(0)
    ds_read2st64_b32 v[8:9], v5 offset0:0 offset1:1
    ds_read2st64_b32 v[10:11], v5 offset0:2 offset1:3
    ds_read2st64_b32 v[12:13], v5 offset0:4 offset1:5
    ds_read2st64_b32 v[14:15], v5 offset0:6 offset1:7
    ds_read2st64_b32 v[16:17], v5 offset0:8 offset1:9
    ds_read2st64_b32 v[18:19], v5 offset0:10 offset1:11
    ds_read2st64_b32 v[20:21], v5 offset0:12 offset1:13
    ds_read2st64_b32 v[22:23], v5 offset0:14 offset1:15
    s_waitcnt lgkmcnt(0)
    v_pk_add_f32 v[8:9], v[8:9], v[10:11]
    v_pk_add_f32 v[8:9], v[8:9], v[12:13]
    v_pk_add_f32 v[8:9], v[8:9], v[14:15]
    v_pk_add_f32 v[8:9], v[8:9], v[16:17]
    v_pk_add_f32 v[8:9], v[8:9], v[18:19]
    v_pk_add_f32 v[8:9], v[8:9], v[20:21]
    v_pk_add_f32 v[8:9], v[8:9], v[22:23]
    v_lshlrev_b32 v5, 3, v0
    ds_write_b64 v5, v[8:9] offset:32768
    v_lshlrev_b32 v5, 1, v6
    s_waitcnt lgkmcnt(0)
    s_barrier
    ds_read_b64 v[8:9], v5 offset:32768
    ds_read_b64 v[10:11], v5 offset:33280
    ds_read_b64 v[12:13], v5 offset:33792
    ds_read_b64 v[14:15], v5 offset:34304
    ds_read_b64 v[16:17], v5 offset:34816
    ds_read_b64 v[18:19], v5 offset:35328
    ds_read_b64 v[20:21], v5 offset:35840
    ds_read_b64 v[22:23], v5 offset:36352
    s_waitcnt lgkmcnt(0)
    v_pk_add_f32 v[8:9], v[8:9], v[10:11]
    v_pk_add_f32 v[8:9], v[8:9], v[12:13]
    v_pk_add_f32 v[8:9], v[8:9], v[14:15]
    v_pk_add_f32 v[8:9], v[8:9], v[16:17]
    v_pk_add_f32 v[8:9], v[8:9], v[18:19]
    v_pk_add_f32 v[8:9], v[8:9], v[20:21]
    v_pk_add_f32 v[8:9], v[8:9], v[22:23]
    v_mul_f32 v8, 0x3acccccd, v8
    v_mul_f32 v9, 0x3acccccd, v9
    v_fma_f32 v9, -v8, v8, v9
    v_max_f32 v9, 0, v9
    v_cvt_pk_bf16_f32 v8, v8, v8
    v_lshlrev_b32 v8, 16, v8
    v_cvt_pk_bf16_f32 v9, v9, v9
    v_lshlrev_b32 v9, 16, v9
    v_add_f32 v9, 0x3727c5ac, v9
    v_cvt_pk_bf16_f32 v9, v9, v9
    v_lshlrev_b32 v9, 16, v9
    v_sqrt_f32 v9, v9
    s_nop 0
    v_cvt_pk_bf16_f32 v9, v9, v9
    v_lshlrev_b32 v9, 16, v9
    v_lshrrev_b32 v9, 16, v9
    v_or_b32 v8, v8, v9
    s_lshl_b32 s4, s2, 8
    s_cmp_lg_u32 s3, 0
    s_cbranch_scc1 C_w2
    buffer_store_dword v8, v6, s[32:35], s4 offen sc0 sc1
C_w2:
    s_mul_i32 s7, s3, 54
    s_add_u32 s7, s7, s2
    s_mul_i32 s7, s7, 5120
    s_waitcnt vmcnt(0)
    s_barrier
    v_mov_b32 v88, v80
    v_mov_b32 v89, v81
    v_mov_b32 v90, v82
    v_mov_b32 v91, v83
    v_mov_b32 v92, v84
    s_nop 0
    v_permlane16_swap_b32 v80, v88
    v_permlane16_swap_b32 v81, v89
    v_permlane16_swap_b32 v82, v90
    v_permlane16_swap_b32 v83, v91
    v_permlane16_swap_b32 v84, v92
    s_nop 0
    v_add_f32 v80, v80, v88
    v_add_f32 v81, v81, v89
    v_add_f32 v82, v82, v90
    v_add_f32 v83, v83, v91
    v_add_f32 v84, v84, v92
    v_mov_b32 v88, v80
    v_mov_b32 v89, v81
    v_mov_b32 v90, v82
    v_mov_b32 v91, v83
    v_mov_b32 v92, v84
    s_nop 0
    v_permlane32_swap_b32 v80, v88
    v_permlane32_swap_b32 v81, v89
    v_permlane32_swap_b32 v82, v90
    v_permlane32_swap_b32 v83, v91
    v_permlane32_swap_b32 v84, v92
    s_nop 0
    v_add_f32 v80, v80, v88
    v_add_f32 v81, v81, v89
    v_add_f32 v82, v82, v90
    v_add_f32 v83, v83, v91
    v_add_f32 v84, v84, v92
    v_cvt_pk_bf16_f32 v80, v80, v80
    v_lshlrev_b32 v80, 16, v80
    v_cvt_pk_bf16_f32 v81, v81, v81
    v_lshlrev_b32 v81, 16, v81
    v_cvt_pk_bf16_f32 v82, v82, v82
    v_lshlrev_b32 v82, 16, v82
    v_cvt_pk_bf16_f32 v83, v83, v83
    v_lshlrev_b32 v83, 16, v83
    v_cvt_pk_bf16_f32 v84, v84, v84
    v_lshlrev_b32 v84, 16, v84
    ds_read_b64_tr_b16 v[12:13], v74 offset:0
    ds_read_b64_tr_b16 v[14:15], v74 offset:20480
    ds_read_b64_tr_b16 v[16:17], v74 offset:8
    ds_read_b64_tr_b16 v[18:19], v74 offset:20488
    ds_read_b64_tr_b16 v[20:21], v74 offset:16
    ds_read_b64_tr_b16 v[22:23], v74 offset:20496
    ds_read_b64_tr_b16 v[24:25], v74 offset:24
    ds_read_b64_tr_b16 v[26:27], v74 offset:20504
    ds_read_b64_tr_b16 v[28:29], v74 offset:32
    ds_read_b64_tr_b16 v[30:31], v74 offset:20512
    s_waitcnt lgkmcnt(8)
    v_lshlrev_b32 v8, 16, v12
    v_and_b32 v9, s6, v12
    v_mul_f32 v8, v8, v80
    v_mul_f32 v9, v9, v80
    v_cvt_pk_bf16_f32 v12, v8, v9
    v_lshlrev_b32 v8, 16, v13
    v_and_b32 v9, s6, v13
    v_mul_f32 v8, v8, v80
    v_mul_f32 v9, v9, v80
    v_cvt_pk_bf16_f32 v13, v8, v9
    v_lshlrev_b32 v8, 16, v14
    v_and_b32 v9, s6, v14
    v_mul_f32 v8, v8, v80
    v_mul_f32 v9, v9, v80
    v_cvt_pk_bf16_f32 v14, v8, v9
    v_lshlrev_b32 v8, 16, v15
    v_and_b32 v9, s6, v15
    v_mul_f32 v8, v8, v80
    v_mul_f32 v9, v9, v80
    v_cvt_pk_bf16_f32 v15, v8, v9
    buffer_store_dwordx4 v[12:15], v75, s[24:27], s7 offen sc0 sc1
    s_add_u32 s7, s7, 1024
    s_waitcnt lgkmcnt(6)
    v_lshlrev_b32 v8, 16, v16
    v_and_b32 v9, s6, v16
    v_mul_f32 v8, v8, v81
    v_mul_f32 v9, v9, v81
    v_cvt_pk_bf16_f32 v16, v8, v9
    v_lshlrev_b32 v8, 16, v17
    v_and_b32 v9, s6, v17
    v_mul_f32 v8, v8, v81
    v_mul_f32 v9, v9, v81
    v_cvt_pk_bf16_f32 v17, v8, v9
    v_lshlrev_b32 v8, 16, v18
    v_and_b32 v9, s6, v18
    v_mul_f32 v8, v8, v81
    v_mul_f32 v9, v9, v81
    v_cvt_pk_bf16_f32 v18, v8, v9
    v_lshlrev_b32 v8, 16, v19
    v_and_b32 v9, s6, v19
    v_mul_f32 v8, v8, v81
    v_mul_f32 v9, v9, v81
    v_cvt_pk_bf16_f32 v19, v8, v9
    buffer_store_dwordx4 v[16:19], v75, s[24:27], s7 offen sc0 sc1
    s_add_u32 s7, s7, 1024
    s_waitcnt lgkmcnt(4)
    v_lshlrev_b32 v8, 16, v20
    v_and_b32 v9, s6, v20
    v_mul_f32 v8, v8, v82
    v_mul_f32 v9, v9, v82
    v_cvt_pk_bf16_f32 v20, v8, v9
    v_lshlrev_b32 v8, 16, v21
    v_and_b32 v9, s6, v21
    v_mul_f32 v8, v8, v82
    v_mul_f32 v9, v9, v82
    v_cvt_pk_bf16_f32 v21, v8, v9
    v_lshlrev_b32 v8, 16, v22
    v_and_b32 v9, s6, v22
    v_mul_f32 v8, v8, v82
    v_mul_f32 v9, v9, v82
    v_cvt_pk_bf16_f32 v22, v8, v9
    v_lshlrev_b32 v8, 16, v23
    v_and_b32 v9, s6, v23
    v_mul_f32 v8, v8, v82
    v_mul_f32 v9, v9, v82
    v_cvt_pk_bf16_f32 v23, v8, v9
    buffer_store_dwordx4 v[20:23], v75, s[24:27], s7 offen sc0 sc1
    s_add_u32 s7, s7, 1024
    s_waitcnt lgkmcnt(2)
    v_lshlrev_b32 v8, 16, v24
    v_and_b32 v9, s6, v24
    v_mul_f32 v8, v8, v83
    v_mul_f32 v9, v9, v83
    v_cvt_pk_bf16_f32 v24, v8, v9
    v_lshlrev_b32 v8, 16, v25
    v_and_b32 v9, s6, v25
    v_mul_f32 v8, v8, v83
    v_mul_f32 v9, v9, v83
    v_cvt_pk_bf16_f32 v25, v8, v9
    v_lshlrev_b32 v8, 16, v26
    v_and_b32 v9, s6, v26
    v_mul_f32 v8, v8, v83
    v_mul_f32 v9, v9, v83
    v_cvt_pk_bf16_f32 v26, v8, v9
    v_lshlrev_b32 v8, 16, v27
    v_and_b32 v9, s6, v27
    v_mul_f32 v8, v8, v83
    v_mul_f32 v9, v9, v83
    v_cvt_pk_bf16_f32 v27, v8, v9
    buffer_store_dwordx4 v[24:27], v75, s[24:27], s7 offen sc0 sc1
    s_add_u32 s7, s7, 1024
    s_waitcnt lgkmcnt(0)
    v_lshlrev_b32 v8, 16, v28
    v_and_b32 v9, s6, v28
    v_mul_f32 v8, v8, v84
    v_mul_f32 v9, v9, v84
    v_cvt_pk_bf16_f32 v28, v8, v9
    v_lshlrev_b32 v8, 16, v29
    v_and_b32 v9, s6, v29
    v_mul_f32 v8, v8, v84
    v_mul_f32 v9, v9, v84
    v_cvt_pk_bf16_f32 v29, v8, v9
    v_lshlrev_b32 v8, 16, v30
    v_and_b32 v9, s6, v30
    v_mul_f32 v8, v8, v84
    v_mul_f32 v9, v9, v84
    v_cvt_pk_bf16_f32 v30, v8, v9
    v_lshlrev_b32 v8, 16, v31
    v_and_b32 v9, s6, v31
    v_mul_f32 v8, v8, v84
    v_mul_f32 v9, v9, v84
    v_cvt_pk_bf16_f32 v31, v8, v9
    buffer_store_dwordx4 v[28:31], v75, s[24:27], s7 offen sc0 sc1
    s_add_u32 s7, s7, 1024
    s_cmp_ge_u32 s2, 22
    s_cbranch_scc1 C_fin
    s_add_u32 s7, s7, 158720
    ds_read_b64_tr_b16 v[32:33], v74 offset:40960
    ds_read_b64_tr_b16 v[34:35], v74 offset:61440
    ds_read_b64_tr_b16 v[36:37], v74 offset:40968
    ds_read_b64_tr_b16 v[38:39], v74 offset:61448
    ds_read_b64_tr_b16 v[40:41], v74 offset:40976
    ds_read_b64_tr_b16 v[42:43], v74 offset:61456
    ds_read_b64_tr_b16 v[44:45], v74 offset:40984
    ds_read_b64_tr_b16 v[46:47], v74 offset:61464
    ds_read_b64_tr_b16 v[48:49], v74 offset:40992
    ds_read_b64_tr_b16 v[50:51], v74 offset:61472
    s_waitcnt lgkmcnt(8)
    v_lshlrev_b32 v8, 16, v32
    v_and_b32 v9, s6, v32
    v_mul_f32 v8, v8, v80
    v_mul_f32 v9, v9, v80
    v_cvt_pk_bf16_f32 v32, v8, v9
    v_lshlrev_b32 v8, 16, v33
    v_and_b32 v9, s6, v33
    v_mul_f32 v8, v8, v80
    v_mul_f32 v9, v9, v80
    v_cvt_pk_bf16_f32 v33, v8, v9
    v_lshlrev_b32 v8, 16, v34
    v_and_b32 v9, s6, v34
    v_mul_f32 v8, v8, v80
    v_mul_f32 v9, v9, v80
    v_cvt_pk_bf16_f32 v34, v8, v9
    v_lshlrev_b32 v8, 16, v35
    v_and_b32 v9, s6, v35
    v_mul_f32 v8, v8, v80
    v_mul_f32 v9, v9, v80
    v_cvt_pk_bf16_f32 v35, v8, v9
    buffer_store_dwordx4 v[32:35], v75, s[24:27], s7 offen sc0 sc1
    s_add_u32 s7, s7, 1024
    s_waitcnt lgkmcnt(6)
    v_lshlrev_b32 v8, 16, v36
    v_and_b32 v9, s6, v36
    v_mul_f32 v8, v8, v81
    v_mul_f32 v9, v9, v81
    v_cvt_pk_bf16_f32 v36, v8, v9
    v_lshlrev_b32 v8, 16, v37
    v_and_b32 v9, s6, v37
    v_mul_f32 v8, v8, v81
    v_mul_f32 v9, v9, v81
    v_cvt_pk_bf16_f32 v37, v8, v9
    v_lshlrev_b32 v8, 16, v38
    v_and_b32 v9, s6, v38
    v_mul_f32 v8, v8, v81
    v_mul_f32 v9, v9, v81
    v_cvt_pk_bf16_f32 v38, v8, v9
    v_lshlrev_b32 v8, 16, v39
    v_and_b32 v9, s6, v39
    v_mul_f32 v8, v8, v81
    v_mul_f32 v9, v9, v81
    v_cvt_pk_bf16_f32 v39, v8, v9
    buffer_store_dwordx4 v[36:39], v75, s[24:27], s7 offen sc0 sc1
    s_add_u32 s7, s7, 1024
    s_waitcnt lgkmcnt(4)
    v_lshlrev_b32 v8, 16, v40
    v_and_b32 v9, s6, v40
    v_mul_f32 v8, v8, v82
    v_mul_f32 v9, v9, v82
    v_cvt_pk_bf16_f32 v40, v8, v9
    v_lshlrev_b32 v8, 16, v41
    v_and_b32 v9, s6, v41
    v_mul_f32 v8, v8, v82
    v_mul_f32 v9, v9, v82
    v_cvt_pk_bf16_f32 v41, v8, v9
    v_lshlrev_b32 v8, 16, v42
    v_and_b32 v9, s6, v42
    v_mul_f32 v8, v8, v82
    v_mul_f32 v9, v9, v82
    v_cvt_pk_bf16_f32 v42, v8, v9
    v_lshlrev_b32 v8, 16, v43
    v_and_b32 v9, s6, v43
    v_mul_f32 v8, v8, v82
    v_mul_f32 v9, v9, v82
    v_cvt_pk_bf16_f32 v43, v8, v9
    buffer_store_dwordx4 v[40:43], v75, s[24:27], s7 offen sc0 sc1
    s_add_u32 s7, s7, 1024
    s_waitcnt lgkmcnt(2)
    v_lshlrev_b32 v8, 16, v44
    v_and_b32 v9, s6, v44
    v_mul_f32 v8, v8, v83
    v_mul_f32 v9, v9, v83
    v_cvt_pk_bf16_f32 v44, v8, v9
    v_lshlrev_b32 v8, 16, v45
    v_and_b32 v9, s6, v45
    v_mul_f32 v8, v8, v83
    v_mul_f32 v9, v9, v83
    v_cvt_pk_bf16_f32 v45, v8, v9
    v_lshlrev_b32 v8, 16, v46
    v_and_b32 v9, s6, v46
    v_mul_f32 v8, v8, v83
    v_mul_f32 v9, v9, v83
    v_cvt_pk_bf16_f32 v46, v8, v9
    v_lshlrev_b32 v8, 16, v47
    v_and_b32 v9, s6, v47
    v_mul_f32 v8, v8, v83
    v_mul_f32 v9, v9, v83
    v_cvt_pk_bf16_f32 v47, v8, v9
    buffer_store_dwordx4 v[44:47], v75, s[24:27], s7 offen sc0 sc1
    s_add_u32 s7, s7, 1024
    s_waitcnt lgkmcnt(0)
    v_lshlrev_b32 v8, 16, v48
    v_and_b32 v9, s6, v48
    v_mul_f32 v8, v8, v84
    v_mul_f32 v9, v9, v84
    v_cvt_pk_bf16_f32 v48, v8, v9
    v_lshlrev_b32 v8, 16, v49
    v_and_b32 v9, s6, v49
    v_mul_f32 v8, v8, v84
    v_mul_f32 v9, v9, v84
    v_cvt_pk_bf16_f32 v49, v8, v9
    v_lshlrev_b32 v8, 16, v50
    v_and_b32 v9, s6, v50
    v_mul_f32 v8, v8, v84
    v_mul_f32 v9, v9, v84
    v_cvt_pk_bf16_f32 v50, v8, v9
    v_lshlrev_b32 v8, 16, v51
    v_and_b32 v9, s6, v51
    v_mul_f32 v8, v8, v84
    v_mul_f32 v9, v9, v84
    v_cvt_pk_bf16_f32 v51, v8, v9
    buffer_store_dwordx4 v[48:51], v75, s[24:27], s7 offen sc0 sc1
    s_add_u32 s7, s7, 1024
C_fin:
C_end:
    s_endpgm
.globl kd_kernel
.p2align 8
.type kd_kernel,@function
kd_kernel:
    s_cmp_ge_u32 s2, 256
    s_cbranch_scc1 D_end
    s_load_dwordx2 s[8:9], s[0:1], 120
    s_load_dwordx2 s[30:31], s[0:1], 104
    s_and_b32 s4, s2, 7
    s_lshl_b32 s4, s4, 2
    s_lshr_b32 s5, s2, 6
    s_add_u32 s4, s4, s5
    s_bfe_u32 s5, s2, 0x30003
    v_lshrrev_b32 v1, 6, v0
    v_and_b32 v0, 63, v0
    s_nop 0
    v_readfirstlane_b32 s40, v1
    s_and_b32 s3, s40, 3
    v_lshlrev_b32 v2, 4, v0
    s_mul_i32 s10, s5, 276480
    s_add_u32 s10, s10, 0xd00000
    s_lshl_b32 s6, s4, 2
    s_add_u32 s6, s6, s3
    s_mul_i32 s11, s6, 55296
    s_add_u32 s11, s11, 0x1000000
    s_lshl_b32 s24, s3, 10
    s_lshl_b32 s26, s3, 10
    s_mov_b32 s25, 0
    s_waitcnt lgkmcnt(0)
    s_add_u32 s12, s8, s10
    s_addc_u32 s13, s9, 0
    s_mov_b32 s14, 0x43800
    s_mov_b32 s15, 0x00020000
    s_add_u32 s16, s8, s11
    s_addc_u32 s17, s9, 0
    s_mov_b32 s18, 0xd800
    s_mov_b32 s19, 0x00020000
    s_add_u32 s20, s8, 0x280000
    s_addc_u32 s21, s9, 0
    s_mov_b32 s22, 0x280000
    s_mov_b32 s23, 0x00020000
    s_add_u32 s32, s8, 0x790000
    s_addc_u32 s33, s9, 0
    s_mov_b32 s34, 0xf000
    s_mov_b32 s35, 0x00020000
    s_mov_b32 s36, s30
    s_mov_b32 s37, s31
    s_mov_b32 s38, 0x280000
    s_mov_b32 s39, 0x00020000
    s_cmp_lt_u32 s40, 4
    s_cbranch_scc1 D_mm
    s_add_u32 m0, s26, 0
    s_nop 0
    buffer_load_dwordx4 v2, s[12:15], s24 offen lds
    s_add_u32 s24, s24, 4096
    s_add_u32 m0, s26, 4096
    s_nop 0
    buffer_load_dwordx4 v2, s[12:15], s24 offen lds
    s_add_u32 s24, s24, 4096
    s_add_u32 m0, s26, 8192
    s_nop 0
    buffer_load_dwordx4 v2, s[12:15], s24 offen lds
    s_add_u32 s24, s24, 4096
    s_add_u32 m0, s26, 12288
    s_nop 0
    buffer_load_dwordx4 v2, s[12:15], s24 offen lds
    s_add_u32 s24, s24, 4096
    s_add_u32 m0, s26, 16384
    s_nop 0
    buffer_load_dwordx4 v2, s[12:15], s24 offen lds
    s_add_u32 s24, s24, 4096
    s_add_u32 m0, s26, 20480
    s_nop 0
    buffer_load_dwordx4 v2, s[12:15], s24 offen lds
    s_add_u32 s24, s24, 4096
    s_add_u32 m0, s26, 24576
    s_nop 0
    buffer_load_dwordx4 v2, s[12:15], s24 offen lds
    s_add_u32 s24, s24, 4096
    s_add_u32 m0, s26, 28672
    s_nop 0
    buffer_load_dwordx4 v2, s[12:15], s24 offen lds
    s_add_u32 s24, s24, 4096
    s_add_u32 m0, s26, 32768
    s_nop 0
    buffer_load_dwordx4 v2, s[12:15], s24 offen lds
    s_add_u32 s24, s24, 4096
    s_add_u32 m0, s26, 36864
    s_nop 0
    buffer_load_dwordx4 v2, s[12:15], s24 offen lds
    s_add_u32 s24, s24, 4096
    s_waitcnt vmcnt(5)
    s_barrier
    s_add_u32 m0, s26, 40960
    s_nop 0
    buffer_load_dwordx4 v2, s[12:15], s24 offen lds
    s_add_u32 s24, s24, 4096
    s_add_u32 m0, s26, 45056
    s_nop 0
    buffer_load_dwordx4 v2, s[12:15], s24 offen lds
    s_add_u32 s24, s24, 4096
    s_add_u32 m0, s26, 49152
    s_nop 0
    buffer_load_dwordx4 v2, s[12:15], s24 offen lds
    s_add_u32 s24, s24, 4096
    s_waitcnt vmcnt(3)
    s_barrier
    s_add_u32 m0, s26, 53248
    s_nop 0
    buffer_load_dwordx4 v2, s[12:15], s24 offen lds
    s_add_u32 s24, s24, 4096
    s_add_u32 m0, s26, 57344
    s_nop 0
    buffer_load_dwordx4 v2, s[12:15], s24 offen lds
    s_add_u32 s24, s24, 4096
    s_add_u32 m0, s26, 61440
    s_nop 0
    buffer_load_dwordx4 v2, s[12:15], s24 offen lds
    s_add_u32 s24, s24, 4096
    s_add_u32 m0, s26, 65536
    s_nop 0
    buffer_load_dwordx4 v2, s[12:15], s24 offen lds
    s_add_u32 s24, s24, 4096
    s_add_u32 m0, s26, 69632
    s_nop 0
    buffer_load_dwordx4 v2, s[12:15], s24 offen lds
    s_add_u32 s24, s24, 4096
    s_add_u32 m0, s26, 73728
    s_nop 0
    buffer_load_dwordx4 v2, s[12:15], s24 offen lds
    s_add_u32 s24, s24, 4096
    s_add_u32 m0, s26, 77824
    s_nop 0
    buffer_load_dwordx4 v2, s[12:15], s24 offen lds
    s_add_u32 s24, s24, 4096
    s_waitcnt vmcnt(5)
    s_barrier
    s_add_u32 m0, s26, 0
    s_nop 0
    buffer_load_dwordx4 v2, s[12:15], s24 offen lds
    s_add_u32 s24, s24, 4096
    s_add_u32 m0, s26, 4096
    s_nop 0
    buffer_load_dwordx4 v2, s[12:15], s24 offen lds
    s_add_u32 s24, s24, 4096
    s_add_u32 m0, s26, 8192
    s_nop 0
    buffer_load_dwordx4 v2, s[12:15], s24 offen lds
    s_add_u32 s24, s24, 4096
    s_add_u32 m0, s26, 12288
    s_nop 0
    buffer_load_dwordx4 v2, s[12:15], s24 offen lds
    s_add_u32 s24, s24, 4096
    s_add_u32 m0, s26, 16384
    s_nop 0
    buffer_load_dwordx4 v2, s[12:15], s24 offen lds
    s_add_u32 s24, s24, 4096
    s_waitcnt vmcnt(5)
    s_barrier
    s_add_u32 m0, s26, 20480
    s_nop 0
    buffer_load_dwordx4 v2, s[12:15], s24 offen lds
    s_add_u32 s24, s24, 4096
    s_add_u32 m0, s26, 24576
    s_nop 0
    buffer_load_dwordx4 v2, s[12:15], s24 offen lds
    s_add_u32 s24, s24, 4096
    s_add_u32 m0, s26, 28672
    s_nop 0
    buffer_load_dwordx4 v2, s[12:15], s24 offen lds
    s_add_u32 s24, s24, 4096
    s_add_u32 m0, s26, 32768
    s_nop 0
    buffer_load_dwordx4 v2, s[12:15], s24 offen lds
    s_add_u32 s24, s24, 4096
    s_add_u32 m0, s26, 36864
    s_nop 0
    buffer_load_dwordx4 v2, s[12:15], s24 offen lds
    s_add_u32 s24, s24, 4096
    s_waitcnt vmcnt(5)
    s_barrier
    s_add_u32 m0, s26, 40960
    s_nop 0
    buffer_load_dwordx4 v2, s[12:15], s24 offen lds
    s_add_u32 s24, s24, 4096
    s_add_u32 m0, s26, 45056
    s_nop 0
    buffer_load_dwordx4 v2, s[12:15], s24 offen lds
    s_add_u32 s24, s24, 4096
    s_add_u32 m0, s26, 49152
    s_nop 0
    buffer_load_dwordx4 v2, s[12:15], s24 offen lds
    s_add_u32 s24, s24, 4096
    s_add_u32 m0, s26, 53248
    s_nop 0
    buffer_load_dwordx4 v2, s[12:15], s24 offen lds
    s_add_u32 s24, s24, 4096
    s_add_u32 m0, s26, 57344
    s_nop 0
    buffer_load_dwordx4 v2, s[12:15], s24 offen lds
    s_add_u32 s24, s24, 4096
    s_waitcnt vmcnt(5)
    s_barrier
    s_add_u32 m0, s26, 61440
    s_nop 0
    buffer_load_dwordx4 v2, s[12:15], s24 offen lds
    s_add_u32 s24, s24, 4096
    s_add_u32 m0, s26, 65536
    s_nop 0
    buffer_load_dwordx4 v2, s[12:15], s24 offen lds
    s_add_u32 s24, s24, 4096
    s_add_u32 m0, s26, 69632
    s_nop 0
    buffer_load_dwordx4 v2, s[12:15], s24 offen lds
    s_add_u32 s24, s24, 4096
    s_add_u32 m0, s26, 73728
    s_nop 0
    buffer_load_dwordx4 v2, s[12:15], s24 offen lds
    s_add_u32 s24, s24, 4096
    s_add_u32 m0, s26, 77824
    s_nop 0
    buffer_load_dwordx4 v2, s[12:15], s24 offen lds
    s_add_u32 s24, s24, 4096
    s_waitcnt vmcnt(5)
    s_barrier
    s_add_u32 m0, s26, 0
    s_nop 0
    buffer_load_dwordx4 v2, s[12:15], s24 offen lds
    s_add_u32 s24, s24, 4096
    s_add_u32 m0, s26, 4096
    s_nop 0
    buffer_load_dwordx4 v2, s[12:15], s24 offen lds
    s_add_u32 s24, s24, 4096
    s_add_u32 m0, s26, 8192
    s_nop 0
    buffer_load_dwordx4 v2, s[12:15], s24 offen lds
    s_add_u32 s24, s24, 4096
    s_add_u32 m0, s26, 12288
    s_nop 0
    buffer_load_dwordx4 v2, s[12:15], s24 offen lds
    s_add_u32 s24, s24, 4096
    s_add_u32 m0, s26, 16384
    s_nop 0
    buffer_load_dwordx4 v2, s[12:15], s24 offen lds
    s_add_u32 s24, s24, 4096
    s_waitcnt vmcnt(5)
    s_barrier
    s_add_u32 m0, s26, 20480
    s_nop 0
    buffer_load_dwordx4 v2, s[12:15], s24 offen lds
    s_add_u32 s24, s24, 4096
    s_add_u32 m0, s26, 24576
    s_nop 0
    buffer_load_dwordx4 v2, s[12:15], s24 offen lds
    s_add_u32 s24, s24, 4096
    s_add_u32 m0, s26, 28672
    s_nop 0
    buffer_load_dwordx4 v2, s[12:15], s24 offen lds
    s_add_u32 s24, s24, 4096
    s_add_u32 m0, s26, 32768
    s_nop 0
    buffer_load_dwordx4 v2, s[12:15], s24 offen lds
    s_add_u32 s24, s24, 4096
    s_add_u32 m0, s26, 36864
    s_nop 0
    buffer_load_dwordx4 v2, s[12:15], s24 offen lds
    s_add_u32 s24, s24, 4096
    s_waitcnt vmcnt(5)
    s_barrier
    s_add_u32 m0, s26, 40960
    s_nop 0
    buffer_load_dwordx4 v2, s[12:15], s24 offen lds
    s_add_u32 s24, s24, 4096
    s_add_u32 m0, s26, 45056
    s_nop 0
    buffer_load_dwordx4 v2, s[12:15], s24 offen lds
    s_add_u32 s24, s24, 4096
    s_add_u32 m0, s26, 49152
    s_nop 0
    buffer_load_dwordx4 v2, s[12:15], s24 offen lds
    s_add_u32 s24, s24, 4096
    s_add_u32 m0, s26, 53248
    s_nop 0
    buffer_load_dwordx4 v2, s[12:15], s24 offen lds
    s_add_u32 s24, s24, 4096
    s_add_u32 m0, s26, 57344
    s_nop 0
    buffer_load_dwordx4 v2, s[12:15], s24 offen lds
    s_add_u32 s24, s24, 4096
    s_waitcnt vmcnt(5)
    s_barrier
    s_add_u32 m0, s26, 61440
    s_nop 0
    buffer_load_dwordx4 v2, s[12:15], s24 offen lds
    s_add_u32 s24, s24, 4096
    s_add_u32 m0, s26, 65536
    s_nop 0
    buffer_load_dwordx4 v2, s[12:15], s24 offen lds
    s_add_u32 s24, s24, 4096
    s_add_u32 m0, s26, 69632
    s_nop 0
    buffer_load_dwordx4 v2, s[12:15], s24 offen lds
    s_add_u32 s24, s24, 4096
    s_add_u32 m0, s26, 73728
    s_nop 0
    buffer_load_dwordx4 v2, s[12:15], s24 offen lds
    s_add_u32 s24, s24, 4096
    s_add_u32 m0, s26, 77824
    s_nop 0
    buffer_load_dwordx4 v2, s[12:15], s24 offen lds
    s_add_u32 s24, s24, 4096
    s_waitcnt vmcnt(5)
    s_barrier
    s_add_u32 m0, s26, 0
    s_nop 0
    buffer_load_dwordx4 v2, s[12:15], s24 offen lds
    s_add_u32 s24, s24, 4096
    s_add_u32 m0, s26, 4096
    s_nop 0
    buffer_load_dwordx4 v2, s[12:15], s24 offen lds
    s_add_u32 s24, s24, 4096
    s_add_u32 m0, s26, 8192
    s_nop 0
    buffer_load_dwordx4 v2, s[12:15], s24 offen lds
    s_add_u32 s24, s24, 4096
    s_add_u32 m0, s26, 12288
    s_nop 0
    buffer_load_dwordx4 v2, s[12:15], s24 offen lds
    s_add_u32 s24, s24, 4096
    s_add_u32 m0, s26, 16384
    s_nop 0
    buffer_load_dwordx4 v2, s[12:15], s24 offen lds
    s_add_u32 s24, s24, 4096
    s_waitcnt vmcnt(5)
    s_barrier
    s_add_u32 m0, s26, 20480
    s_nop 0
    buffer_load_dwordx4 v2, s[12:15], s24 offen lds
    s_add_u32 s24, s24, 4096
    s_add_u32 m0, s26, 24576
    s_nop 0
    buffer_load_dwordx4 v2, s[12:15], s24 offen lds
    s_add_u32 s24, s24, 4096
    s_add_u32 m0, s26, 28672
    s_nop 0
    buffer_load_dwordx4 v2, s[12:15], s24 offen lds
    s_add_u32 s24, s24, 4096
    s_waitcnt vmcnt(3)
    s_barrier
    s_waitcnt vmcnt(0)
    s_barrier
    s_endpgm
D_mm:
    buffer_load_dwordx4 v[128:131], v2, s[16:19], s25 offen offset:0
    buffer_load_dwordx4 v[132:135], v2, s[16:19], s25 offen offset:1024
    buffer_load_dwordx4 v[136:139], v2, s[16:19], s25 offen offset:2048
    buffer_load_dwordx4 v[140:143], v2, s[16:19], s25 offen offset:3072
    s_add_u32 s25, s25, 4096
    buffer_load_dwordx4 v[144:147], v2, s[16:19], s25 offen offset:0
    buffer_load_dwordx4 v[148:151], v2, s[16:19], s25 offen offset:1024
    buffer_load_dwordx4 v[152:155], v2, s[16:19], s25 offen offset:2048
    buffer_load_dwordx4 v[156:159], v2, s[16:19], s25 offen offset:3072
    s_add_u32 s25, s25, 4096
    v_lshrrev_b32 v3, 4, v0
    v_and_b32 v4, 15, v0
    v_mul_u32_u24 v5, 81920, v3
    v_lshl_add_u32 v5, v4, 1, v5
    v_mul_u32_u24 v6, 80, v3
    s_mul_i32 s7, s3, 2816
    s_add_u32 s7, s7, 81920
    v_mul_u32_u24 v3, 40, v3
    v_mul_u32_u24 v7, 176, v4
    v_add3_u32 v3, v3, v7, s7
    v_add_u32 v6, 0, v0
    v_mul_u32_u24 v7, 6554, v6
    v_lshrrev_b32 v7, 16, v7
    v_mul_u32_u24 v1, 10, v7
    v_sub_u32 v6, v6, v1
    v_lshlrev_b32 v6, 4, v6
    v_min_u32 v1, 15, v7
    v_mul_u32_u24 v1, 176, v1
    v_add3_u32 v108, v1, v6, s7
    v_bfe_u32 v1, v7, 2, 1
    v_lshlrev_b32 v1, 8, v1
    v_and_b32 v28, 3, v7
    v_add_u32 v1, v1, v28
    v_bfe_u32 v28, v7, 3, 1
    v_lshl_add_u32 v1, v28, 4, v1
    v_lshrrev_b32 v28, 4, v7
    v_lshl_add_u32 v1, v28, 12, v1
    v_mul_u32_u24 v1, 1280, v1
    v_add_u32 v111, v1, v6
    v_add_u32 v6, 64, v0
    v_mul_u32_u24 v7, 6554, v6
    v_lshrrev_b32 v7, 16, v7
    v_mul_u32_u24 v1, 10, v7
    v_sub_u32 v6, v6, v1
    v_lshlrev_b32 v6, 4, v6
    v_min_u32 v1, 15, v7
    v_mul_u32_u24 v1, 176, v1
    v_add3_u32 v109, v1, v6, s7
    v_bfe_u32 v1, v7, 2, 1
    v_lshlrev_b32 v1, 8, v1
    v_and_b32 v28, 3, v7
    v_add_u32 v1, v1, v28
    v_bfe_u32 v28, v7, 3, 1
    v_lshl_add_u32 v1, v28, 4, v1
    v_lshrrev_b32 v28, 4, v7
    v_lshl_add_u32 v1, v28, 12, v1
    v_mul_u32_u24 v1, 1280, v1
    v_add_u32 v112, v1, v6
    v_add_u32 v6, 128, v0
    v_mul_u32_u24 v7, 6554, v6
    v_lshrrev_b32 v7, 16, v7
    v_mul_u32_u24 v1, 10, v7
    v_sub_u32 v6, v6, v1
    v_lshlrev_b32 v6, 4, v6
    v_min_u32 v1, 15, v7
    v_mul_u32_u24 v1, 176, v1
    v_add3_u32 v110, v1, v6, s7
    v_bfe_u32 v1, v7, 2, 1
    v_lshlrev_b32 v1, 8, v1
    v_and_b32 v28, 3, v7
    v_add_u32 v1, v1, v28
    v_bfe_u32 v28, v7, 3, 1
    v_lshl_add_u32 v1, v28, 4, v1
    v_lshrrev_b32 v28, 4, v7
    v_lshl_add_u32 v1, v28, 12, v1
    v_mul_u32_u24 v1, 1280, v1
    v_add_u32 v113, v1, v6
    s_mul_i32 s27, s5, 327680
    s_lshl_b32 s7, s6, 5
    s_add_u32 s27, s27, s7
    s_mul_i32 s28, s5, 320
    s_add_u32 s28, s28, 12800
    s_lshr_b32 s29, s6, 5
    s_lshl_b32 s29, s29, 9
    s_and_b32 s7, s6, 7
    s_lshl_b32 s7, s7, 5
    s_add_u32 s29, s29, s7
    s_bfe_u32 s7, s6, 0x20003
    s_lshl_b32 s7, s7, 2
    s_add_u32 s29, s29, s7
    s_mul_i32 s29, s29, 1280
    s_mul_i32 s7, s5, 160
    s_add_u32 s29, s29, s7
    v_add_u32 v1, 61440, v2
    buffer_load_ushort v88, v5, s[20:23], s27 offen
    s_add_u32 s27, s27, 4096
    buffer_load_ushort v89, v5, s[20:23], s27 offen
    s_add_u32 s27, s27, 4096
    buffer_load_ushort v90, v5, s[20:23], s27 offen
    s_add_u32 s27, s27, 4096
    buffer_load_ushort v91, v5, s[20:23], s27 offen
    s_add_u32 s27, s27, 4096
    buffer_load_ushort v92, v5, s[20:23], s27 offen
    s_add_u32 s27, s27, 4096
    buffer_load_ushort v93, v5, s[20:23], s27 offen
    s_add_u32 s27, s27, 4096
    buffer_load_ushort v94, v5, s[20:23], s27 offen
    s_add_u32 s27, s27, 4096
    buffer_load_ushort v95, v5, s[20:23], s27 offen
    s_add_u32 s27, s27, 4096
    buffer_load_ushort v96, v5, s[20:23], s27 offen
    s_add_u32 s27, s27, 4096
    buffer_load_ushort v97, v5, s[20:23], s27 offen
    s_add_u32 s27, s27, 4096
    buffer_load_ushort v98, v5, s[20:23], s27 offen
    s_add_u32 s27, s27, 4096
    buffer_load_ushort v99, v5, s[20:23], s27 offen
    s_add_u32 s27, s27, 4096
    buffer_load_ushort v100, v5, s[20:23], s27 offen
    s_add_u32 s27, s27, 4096
    buffer_load_ushort v101, v5, s[20:23], s27 offen
    s_add_u32 s27, s27, 4096
    buffer_load_ushort v102, v5, s[20:23], s27 offen
    s_add_u32 s27, s27, 4096
    buffer_load_ushort v103, v5, s[20:23], s27 offen
    s_add_u32 s27, s27, 4096
    buffer_load_ushort v104, v5, s[20:23], s27 offen
    s_add_u32 s27, s27, 4096
    buffer_load_ushort v105, v5, s[20:23], s27 offen
    s_add_u32 s27, s27, 4096
    buffer_load_ushort v106, v5, s[20:23], s27 offen
    s_add_u32 s27, s27, 4096
    buffer_load_ushort v107, v5, s[20:23], s27 offen
    s_add_u32 s27, s27, 4096
    s_waitcnt vmcnt(24)
    s_barrier
    ds_read_b128 v[28:31], v2 offset:0
    ds_read_b128 v[32:35], v2 offset:1024
    ds_read_b128 v[36:39], v2 offset:2048
    ds_read_b128 v[40:43], v2 offset:3072
    ds_read_b128 v[44:47], v2 offset:4096
    ds_read_b128 v[48:51], v2 offset:5120
    ds_read_b128 v[52:55], v2 offset:6144
    ds_read_b128 v[56:59], v2 offset:7168
    ds_read_b128 v[60:63], v2 offset:8192
    ds_read_b128 v[64:67], v2 offset:9216
    s_waitcnt lgkmcnt(5)
    v_mfma_f32_16x16x32_bf16 v[8:11], v[28:31], v[128:131], 0
    ds_read_b128 v[68:71], v2 offset:10240
    v_mfma_f32_16x16x32_bf16 v[12:15], v[32:35], v[128:131], 0
    ds_read_b128 v[72:75], v2 offset:11264
    v_mfma_f32_16x16x32_bf16 v[16:19], v[36:39], v[128:131], 0
    ds_read_b128 v[76:79], v2 offset:12288
    buffer_load_dwordx4 v[160:163], v2, s[16:19], s25 offen offset:0
    v_mfma_f32_16x16x32_bf16 v[20:23], v[40:43], v[128:131], 0
    ds_read_b128 v[80:83], v2 offset:13312
    buffer_load_dwordx4 v[164:167], v2, s[16:19], s25 offen offset:1024
    v_mfma_f32_16x16x32_bf16 v[24:27], v[44:47], v[128:131], 0
    ds_read_b128 v[84:87], v2 offset:14336
    buffer_load_dwordx4 v[168:171], v2, s[16:19], s25 offen offset:2048
    s_waitcnt lgkmcnt(5)
    v_mfma_f32_16x16x32_bf16 v[8:11], v[48:51], v[132:135], v[8:11]
    ds_read_b128 v[192:195], v2 offset:15360
    v_mfma_f32_16x16x32_bf16 v[12:15], v[52:55], v[132:135], v[12:15]
    ds_read_b128 v[196:199], v2 offset:16384
    v_mfma_f32_16x16x32_bf16 v[16:19], v[56:59], v[132:135], v[16:19]
    ds_read_b128 v[200:203], v2 offset:17408
    buffer_load_dwordx4 v[172:175], v2, s[16:19], s25 offen offset:3072
    s_add_u32 s25, s25, 4096
    v_mfma_f32_16x16x32_bf16 v[20:23], v[60:63], v[132:135], v[20:23]
    ds_read_b128 v[204:207], v2 offset:18432
    buffer_load_dwordx4 v[176:179], v2, s[16:19], s25 offen offset:0
    v_mfma_f32_16x16x32_bf16 v[24:27], v[64:67], v[132:135], v[24:27]
    ds_read_b128 v[208:211], v2 offset:19456
    buffer_load_dwordx4 v[180:183], v2, s[16:19], s25 offen offset:1024
    s_waitcnt vmcnt(26) lgkmcnt(5)
    s_barrier
    v_mfma_f32_16x16x32_bf16 v[8:11], v[68:71], v[136:139], v[8:11]
    ds_read_b128 v[28:31], v2 offset:20480
    v_mfma_f32_16x16x32_bf16 v[12:15], v[72:75], v[136:139], v[12:15]
    ds_read_b128 v[32:35], v2 offset:21504
    v_mfma_f32_16x16x32_bf16 v[16:19], v[76:79], v[136:139], v[16:19]
    ds_read_b128 v[36:39], v2 offset:22528
    buffer_load_dwordx4 v[184:187], v2, s[16:19], s25 offen offset:2048
    v_mfma_f32_16x16x32_bf16 v[20:23], v[80:83], v[136:139], v[20:23]
    ds_read_b128 v[40:43], v2 offset:23552
    buffer_load_dwordx4 v[188:191], v2, s[16:19], s25 offen offset:3072
    s_add_u32 s25, s25, 4096
    v_mfma_f32_16x16x32_bf16 v[24:27], v[84:87], v[136:139], v[24:27]
    ds_read_b128 v[44:47], v2 offset:24576
    s_waitcnt lgkmcnt(5)
    v_mfma_f32_16x16x32_bf16 v[8:11], v[192:195], v[140:143], v[8:11]
    ds_read_b128 v[48:51], v2 offset:25600
    v_mfma_f32_16x16x32_bf16 v[12:15], v[196:199], v[140:143], v[12:15]
    ds_read_b128 v[52:55], v2 offset:26624
    v_mfma_f32_16x16x32_bf16 v[16:19], v[200:203], v[140:143], v[16:19]
    ds_read_b128 v[56:59], v2 offset:27648
    v_mfma_f32_16x16x32_bf16 v[20:23], v[204:207], v[140:143], v[20:23]
    ds_read_b128 v[60:63], v2 offset:28672
    v_mfma_f32_16x16x32_bf16 v[24:27], v[208:211], v[140:143], v[24:27]
    ds_read_b128 v[64:67], v2 offset:29696
    s_waitcnt lgkmcnt(5)
    v_mfma_f32_16x16x32_bf16 v[8:11], v[28:31], v[144:147], v[8:11]
    ds_read_b128 v[68:71], v2 offset:30720
    v_mfma_f32_16x16x32_bf16 v[12:15], v[32:35], v[144:147], v[12:15]
    ds_read_b128 v[72:75], v2 offset:31744
    v_mfma_f32_16x16x32_bf16 v[16:19], v[36:39], v[144:147], v[16:19]
    ds_read_b128 v[76:79], v2 offset:32768
    v_mfma_f32_16x16x32_bf16 v[20:23], v[40:43], v[144:147], v[20:23]
    ds_read_b128 v[80:83], v2 offset:33792
    v_mfma_f32_16x16x32_bf16 v[24:27], v[44:47], v[144:147], v[24:27]
    ds_read_b128 v[84:87], v2 offset:34816
    s_waitcnt lgkmcnt(5)
    v_mfma_f32_16x16x32_bf16 v[8:11], v[48:51], v[148:151], v[8:11]
    ds_read_b128 v[192:195], v2 offset:35840
    v_mfma_f32_16x16x32_bf16 v[12:15], v[52:55], v[148:151], v[12:15]
    ds_read_b128 v[196:199], v2 offset:36864
    v_mfma_f32_16x16x32_bf16 v[16:19], v[56:59], v[148:151], v[16:19]
    ds_read_b128 v[200:203], v2 offset:37888
    v_mfma_f32_16x16x32_bf16 v[20:23], v[60:63], v[148:151], v[20:23]
    ds_read_b128 v[204:207], v2 offset:38912
    v_mfma_f32_16x16x32_bf16 v[24:27], v[64:67], v[148:151], v[24:27]
    ds_read_b128 v[208:211], v2 offset:39936
    s_waitcnt vmcnt(4) lgkmcnt(5)
    s_barrier
    v_mfma_f32_16x16x32_bf16 v[8:11], v[68:71], v[152:155], v[8:11]
    ds_read_b128 v[28:31], v2 offset:40960
    v_mfma_f32_16x16x32_bf16 v[12:15], v[72:75], v[152:155], v[12:15]
    ds_read_b128 v[32:35], v2 offset:41984
    v_mfma_f32_16x16x32_bf16 v[16:19], v[76:79], v[152:155], v[16:19]
    ds_read_b128 v[36:39], v2 offset:43008
    buffer_load_dwordx4 v[128:131], v2, s[16:19], s25 offen offset:0
    v_mfma_f32_16x16x32_bf16 v[20:23], v[80:83], v[152:155], v[20:23]
    ds_read_b128 v[40:43], v2 offset:44032
    buffer_load_dwordx4 v[132:135], v2, s[16:19], s25 offen offset:1024
    v_mfma_f32_16x16x32_bf16 v[24:27], v[84:87], v[152:155], v[24:27]
    ds_read_b128 v[44:47], v2 offset:45056
    buffer_load_dwordx4 v[136:139], v2, s[16:19], s25 offen offset:2048
    s_waitcnt lgkmcnt(5)
    v_mfma_f32_16x16x32_bf16 v[8:11], v[192:195], v[156:159], v[8:11]
    ds_read_b128 v[48:51], v2 offset:46080
    v_mfma_f32_16x16x32_bf16 v[12:15], v[196:199], v[156:159], v[12:15]
    ds_read_b128 v[52:55], v2 offset:47104
    v_mfma_f32_16x16x32_bf16 v[16:19], v[200:203], v[156:159], v[16:19]
    ds_read_b128 v[56:59], v2 offset:48128
    buffer_load_dwordx4 v[140:143], v2, s[16:19], s25 offen offset:3072
    s_add_u32 s25, s25, 4096
    v_mfma_f32_16x16x32_bf16 v[20:23], v[204:207], v[156:159], v[20:23]
    ds_read_b128 v[60:63], v2 offset:49152
    v_mfma_f32_16x16x32_bf16 v[24:27], v[208:211], v[156:159], v[24:27]
    ds_read_b128 v[64:67], v2 offset:50176
    s_waitcnt lgkmcnt(5)
    v_mfma_f32_16x16x32_bf16 v[8:11], v[28:31], v[160:163], v[8:11]
    ds_read_b128 v[68:71], v2 offset:51200
    v_mfma_f32_16x16x32_bf16 v[12:15], v[32:35], v[160:163], v[12:15]
    ds_read_b128 v[72:75], v2 offset:52224
    v_mfma_f32_16x16x32_bf16 v[16:19], v[36:39], v[160:163], v[16:19]
    ds_read_b128 v[76:79], v2 offset:53248
    v_mfma_f32_16x16x32_bf16 v[20:23], v[40:43], v[160:163], v[20:23]
    ds_read_b128 v[80:83], v2 offset:54272
    v_mfma_f32_16x16x32_bf16 v[24:27], v[44:47], v[160:163], v[24:27]
    ds_read_b128 v[84:87], v2 offset:55296
    s_waitcnt lgkmcnt(5)
    v_mfma_f32_16x16x32_bf16 v[8:11], v[48:51], v[164:167], v[8:11]
    ds_read_b128 v[192:195], v2 offset:56320
    v_mfma_f32_16x16x32_bf16 v[12:15], v[52:55], v[164:167], v[12:15]
    ds_read_b128 v[196:199], v2 offset:57344
    v_mfma_f32_16x16x32_bf16 v[16:19], v[56:59], v[164:167], v[16:19]
    ds_read_b128 v[200:203], v2 offset:58368
    v_mfma_f32_16x16x32_bf16 v[20:23], v[60:63], v[164:167], v[20:23]
    ds_read_b128 v[204:207], v2 offset:59392
    v_mfma_f32_16x16x32_bf16 v[24:27], v[64:67], v[164:167], v[24:27]
    ds_read_b128 v[208:211], v2 offset:60416
    s_mov_b32 s41, 2
D_loop:
    s_waitcnt vmcnt(4) lgkmcnt(5)
    s_barrier
    v_mfma_f32_16x16x32_bf16 v[8:11], v[68:71], v[168:171], v[8:11]
    ds_read_b128 v[28:31], v1 offset:0
    v_mfma_f32_16x16x32_bf16 v[12:15], v[72:75], v[168:171], v[12:15]
    ds_read_b128 v[32:35], v1 offset:1024
    v_mfma_f32_16x16x32_bf16 v[16:19], v[76:79], v[168:171], v[16:19]
    ds_read_b128 v[36:39], v1 offset:2048
    buffer_load_dwordx4 v[144:147], v2, s[16:19], s25 offen offset:0
    v_mfma_f32_16x16x32_bf16 v[20:23], v[80:83], v[168:171], v[20:23]
    ds_read_b128 v[40:43], v1 offset:3072
    buffer_load_dwordx4 v[148:151], v2, s[16:19], s25 offen offset:1024
    v_mfma_f32_16x16x32_bf16 v[24:27], v[84:87], v[168:171], v[24:27]
    ds_read_b128 v[44:47], v1 offset:4096
    buffer_load_dwordx4 v[152:155], v2, s[16:19], s25 offen offset:2048
    s_waitcnt lgkmcnt(5)
    v_mfma_f32_16x16x32_bf16 v[8:11], v[192:195], v[172:175], v[8:11]
    ds_read_b128 v[48:51], v1 offset:5120
    v_mfma_f32_16x16x32_bf16 v[12:15], v[196:199], v[172:175], v[12:15]
    ds_read_b128 v[52:55], v1 offset:6144
    v_mfma_f32_16x16x32_bf16 v[16:19], v[200:203], v[172:175], v[16:19]
    ds_read_b128 v[56:59], v1 offset:7168
    buffer_load_dwordx4 v[156:159], v2, s[16:19], s25 offen offset:3072
    s_add_u32 s25, s25, 4096
    v_mfma_f32_16x16x32_bf16 v[20:23], v[204:207], v[172:175], v[20:23]
    ds_read_b128 v[60:63], v1 offset:8192
    v_mfma_f32_16x16x32_bf16 v[24:27], v[208:211], v[172:175], v[24:27]
    ds_read_b128 v[64:67], v1 offset:9216
    s_waitcnt lgkmcnt(5)
    v_mfma_f32_16x16x32_bf16 v[8:11], v[28:31], v[176:179], v[8:11]
    ds_read_b128 v[68:71], v1 offset:10240
    v_mfma_f32_16x16x32_bf16 v[12:15], v[32:35], v[176:179], v[12:15]
    ds_read_b128 v[72:75], v1 offset:11264
    v_mfma_f32_16x16x32_bf16 v[16:19], v[36:39], v[176:179], v[16:19]
    ds_read_b128 v[76:79], v1 offset:12288
    v_mfma_f32_16x16x32_bf16 v[20:23], v[40:43], v[176:179], v[20:23]
    ds_read_b128 v[80:83], v1 offset:13312
    v_mfma_f32_16x16x32_bf16 v[24:27], v[44:47], v[176:179], v[24:27]
    ds_read_b128 v[84:87], v1 offset:14336
    s_waitcnt lgkmcnt(5)
    v_mfma_f32_16x16x32_bf16 v[8:11], v[48:51], v[180:183], v[8:11]
    ds_read_b128 v[192:195], v1 offset:15360
    v_mfma_f32_16x16x32_bf16 v[12:15], v[52:55], v[180:183], v[12:15]
    ds_read_b128 v[196:199], v1 offset:16384
    v_mfma_f32_16x16x32_bf16 v[16:19], v[56:59], v[180:183], v[16:19]
    ds_read_b128 v[200:203], v1 offset:17408
    v_mfma_f32_16x16x32_bf16 v[20:23], v[60:63], v[180:183], v[20:23]
    ds_read_b128 v[204:207], v1 offset:18432
    v_mfma_f32_16x16x32_bf16 v[24:27], v[64:67], v[180:183], v[24:27]
    ds_read_b128 v[208:211], v1 offset:19456
    s_waitcnt vmcnt(4) lgkmcnt(5)
    s_barrier
    v_mfma_f32_16x16x32_bf16 v[8:11], v[68:71], v[184:187], v[8:11]
    ds_read_b128 v[28:31], v2 offset:0
    v_mfma_f32_16x16x32_bf16 v[12:15], v[72:75], v[184:187], v[12:15]
    ds_read_b128 v[32:35], v2 offset:1024
    v_mfma_f32_16x16x32_bf16 v[16:19], v[76:79], v[184:187], v[16:19]
    ds_read_b128 v[36:39], v2 offset:2048
    buffer_load_dwordx4 v[160:163], v2, s[16:19], s25 offen offset:0
    v_mfma_f32_16x16x32_bf16 v[20:23], v[80:83], v[184:187], v[20:23]
    ds_read_b128 v[40:43], v2 offset:3072
    buffer_load_dwordx4 v[164:167], v2, s[16:19], s25 offen offset:1024
    v_mfma_f32_16x16x32_bf16 v[24:27], v[84:87], v[184:187], v[24:27]
    ds_read_b128 v[44:47], v2 offset:4096
    buffer_load_dwordx4 v[168:171], v2, s[16:19], s25 offen offset:2048
    s_waitcnt lgkmcnt(5)
    v_mfma_f32_16x16x32_bf16 v[8:11], v[192:195], v[188:191], v[8:11]
    ds_read_b128 v[48:51], v2 offset:5120
    v_mfma_f32_16x16x32_bf16 v[12:15], v[196:199], v[188:191], v[12:15]
    ds_read_b128 v[52:55], v2 offset:6144
    v_mfma_f32_16x16x32_bf16 v[16:19], v[200:203], v[188:191], v[16:19]
    ds_read_b128 v[56:59], v2 offset:7168
    buffer_load_dwordx4 v[172:175], v2, s[16:19], s25 offen offset:3072
    s_add_u32 s25, s25, 4096
    v_mfma_f32_16x16x32_bf16 v[20:23], v[204:207], v[188:191], v[20:23]
    ds_read_b128 v[60:63], v2 offset:8192
    v_mfma_f32_16x16x32_bf16 v[24:27], v[208:211], v[188:191], v[24:27]
    ds_read_b128 v[64:67], v2 offset:9216
    s_waitcnt lgkmcnt(5)
    v_mfma_f32_16x16x32_bf16 v[8:11], v[28:31], v[128:131], v[8:11]
    ds_read_b128 v[68:71], v2 offset:10240
    v_mfma_f32_16x16x32_bf16 v[12:15], v[32:35], v[128:131], v[12:15]
    ds_read_b128 v[72:75], v2 offset:11264
    v_mfma_f32_16x16x32_bf16 v[16:19], v[36:39], v[128:131], v[16:19]
    ds_read_b128 v[76:79], v2 offset:12288
    v_mfma_f32_16x16x32_bf16 v[20:23], v[40:43], v[128:131], v[20:23]
    ds_read_b128 v[80:83], v2 offset:13312
    v_mfma_f32_16x16x32_bf16 v[24:27], v[44:47], v[128:131], v[24:27]
    ds_read_b128 v[84:87], v2 offset:14336
    s_waitcnt lgkmcnt(5)
    v_mfma_f32_16x16x32_bf16 v[8:11], v[48:51], v[132:135], v[8:11]
    ds_read_b128 v[192:195], v2 offset:15360
    v_mfma_f32_16x16x32_bf16 v[12:15], v[52:55], v[132:135], v[12:15]
    ds_read_b128 v[196:199], v2 offset:16384
    v_mfma_f32_16x16x32_bf16 v[16:19], v[56:59], v[132:135], v[16:19]
    ds_read_b128 v[200:203], v2 offset:17408
    v_mfma_f32_16x16x32_bf16 v[20:23], v[60:63], v[132:135], v[20:23]
    ds_read_b128 v[204:207], v2 offset:18432
    v_mfma_f32_16x16x32_bf16 v[24:27], v[64:67], v[132:135], v[24:27]
    ds_read_b128 v[208:211], v2 offset:19456
    s_waitcnt vmcnt(4) lgkmcnt(5)
    s_barrier
    v_mfma_f32_16x16x32_bf16 v[8:11], v[68:71], v[136:139], v[8:11]
    ds_read_b128 v[28:31], v2 offset:20480
    v_mfma_f32_16x16x32_bf16 v[12:15], v[72:75], v[136:139], v[12:15]
    ds_read_b128 v[32:35], v2 offset:21504
    v_mfma_f32_16x16x32_bf16 v[16:19], v[76:79], v[136:139], v[16:19]
    ds_read_b128 v[36:39], v2 offset:22528
    buffer_load_dwordx4 v[176:179], v2, s[16:19], s25 offen offset:0
    v_mfma_f32_16x16x32_bf16 v[20:23], v[80:83], v[136:139], v[20:23]
    ds_read_b128 v[40:43], v2 offset:23552
    buffer_load_dwordx4 v[180:183], v2, s[16:19], s25 offen offset:1024
    v_mfma_f32_16x16x32_bf16 v[24:27], v[84:87], v[136:139], v[24:27]
    ds_read_b128 v[44:47], v2 offset:24576
    buffer_load_dwordx4 v[184:187], v2, s[16:19], s25 offen offset:2048
    s_waitcnt lgkmcnt(5)
    v_mfma_f32_16x16x32_bf16 v[8:11], v[192:195], v[140:143], v[8:11]
    ds_read_b128 v[48:51], v2 offset:25600
    v_mfma_f32_16x16x32_bf16 v[12:15], v[196:199], v[140:143], v[12:15]
    ds_read_b128 v[52:55], v2 offset:26624
    v_mfma_f32_16x16x32_bf16 v[16:19], v[200:203], v[140:143], v[16:19]
    ds_read_b128 v[56:59], v2 offset:27648
    buffer_load_dwordx4 v[188:191], v2, s[16:19], s25 offen offset:3072
    s_add_u32 s25, s25, 4096
    v_mfma_f32_16x16x32_bf16 v[20:23], v[204:207], v[140:143], v[20:23]
    ds_read_b128 v[60:63], v2 offset:28672
    v_mfma_f32_16x16x32_bf16 v[24:27], v[208:211], v[140:143], v[24:27]
    ds_read_b128 v[64:67], v2 offset:29696
    s_waitcnt lgkmcnt(5)
    v_mfma_f32_16x16x32_bf16 v[8:11], v[28:31], v[144:147], v[8:11]
    ds_read_b128 v[68:71], v2 offset:30720
    v_mfma_f32_16x16x32_bf16 v[12:15], v[32:35], v[144:147], v[12:15]
    ds_read_b128 v[72:75], v2 offset:31744
    v_mfma_f32_16x16x32_bf16 v[16:19], v[36:39], v[144:147], v[16:19]
    ds_read_b128 v[76:79], v2 offset:32768
    v_mfma_f32_16x16x32_bf16 v[20:23], v[40:43], v[144:147], v[20:23]
    ds_read_b128 v[80:83], v2 offset:33792
    v_mfma_f32_16x16x32_bf16 v[24:27], v[44:47], v[144:147], v[24:27]
    ds_read_b128 v[84:87], v2 offset:34816
    s_waitcnt lgkmcnt(5)
    v_mfma_f32_16x16x32_bf16 v[8:11], v[48:51], v[148:151], v[8:11]
    ds_read_b128 v[192:195], v2 offset:35840
    v_mfma_f32_16x16x32_bf16 v[12:15], v[52:55], v[148:151], v[12:15]
    ds_read_b128 v[196:199], v2 offset:36864
    v_mfma_f32_16x16x32_bf16 v[16:19], v[56:59], v[148:151], v[16:19]
    ds_read_b128 v[200:203], v2 offset:37888
    v_mfma_f32_16x16x32_bf16 v[20:23], v[60:63], v[148:151], v[20:23]
    ds_read_b128 v[204:207], v2 offset:38912
    v_mfma_f32_16x16x32_bf16 v[24:27], v[64:67], v[148:151], v[24:27]
    ds_read_b128 v[208:211], v2 offset:39936
    s_waitcnt vmcnt(4) lgkmcnt(5)
    s_barrier
    v_mfma_f32_16x16x32_bf16 v[8:11], v[68:71], v[152:155], v[8:11]
    ds_read_b128 v[28:31], v2 offset:40960
    v_mfma_f32_16x16x32_bf16 v[12:15], v[72:75], v[152:155], v[12:15]
    ds_read_b128 v[32:35], v2 offset:41984
    v_mfma_f32_16x16x32_bf16 v[16:19], v[76:79], v[152:155], v[16:19]
    ds_read_b128 v[36:39], v2 offset:43008
    buffer_load_dwordx4 v[128:131], v2, s[16:19], s25 offen offset:0
    v_mfma_f32_16x16x32_bf16 v[20:23], v[80:83], v[152:155], v[20:23]
    ds_read_b128 v[40:43], v2 offset:44032
    buffer_load_dwordx4 v[132:135], v2, s[16:19], s25 offen offset:1024
    v_mfma_f32_16x16x32_bf16 v[24:27], v[84:87], v[152:155], v[24:27]
    ds_read_b128 v[44:47], v2 offset:45056
    buffer_load_dwordx4 v[136:139], v2, s[16:19], s25 offen offset:2048
    s_waitcnt lgkmcnt(5)
    v_mfma_f32_16x16x32_bf16 v[8:11], v[192:195], v[156:159], v[8:11]
    ds_read_b128 v[48:51], v2 offset:46080
    v_mfma_f32_16x16x32_bf16 v[12:15], v[196:199], v[156:159], v[12:15]
    ds_read_b128 v[52:55], v2 offset:47104
    v_mfma_f32_16x16x32_bf16 v[16:19], v[200:203], v[156:159], v[16:19]
    ds_read_b128 v[56:59], v2 offset:48128
    buffer_load_dwordx4 v[140:143], v2, s[16:19], s25 offen offset:3072
    s_add_u32 s25, s25, 4096
    v_mfma_f32_16x16x32_bf16 v[20:23], v[204:207], v[156:159], v[20:23]
    ds_read_b128 v[60:63], v2 offset:49152
    v_mfma_f32_16x16x32_bf16 v[24:27], v[208:211], v[156:159], v[24:27]
    ds_read_b128 v[64:67], v2 offset:50176
    s_waitcnt lgkmcnt(5)
    v_mfma_f32_16x16x32_bf16 v[8:11], v[28:31], v[160:163], v[8:11]
    ds_read_b128 v[68:71], v2 offset:51200
    v_mfma_f32_16x16x32_bf16 v[12:15], v[32:35], v[160:163], v[12:15]
    ds_read_b128 v[72:75], v2 offset:52224
    v_mfma_f32_16x16x32_bf16 v[16:19], v[36:39], v[160:163], v[16:19]
    ds_read_b128 v[76:79], v2 offset:53248
    v_mfma_f32_16x16x32_bf16 v[20:23], v[40:43], v[160:163], v[20:23]
    ds_read_b128 v[80:83], v2 offset:54272
    v_mfma_f32_16x16x32_bf16 v[24:27], v[44:47], v[160:163], v[24:27]
    ds_read_b128 v[84:87], v2 offset:55296
    s_waitcnt lgkmcnt(5)
    v_mfma_f32_16x16x32_bf16 v[8:11], v[48:51], v[164:167], v[8:11]
    ds_read_b128 v[192:195], v2 offset:56320
    v_mfma_f32_16x16x32_bf16 v[12:15], v[52:55], v[164:167], v[12:15]
    ds_read_b128 v[196:199], v2 offset:57344
    v_mfma_f32_16x16x32_bf16 v[16:19], v[56:59], v[164:167], v[16:19]
    ds_read_b128 v[200:203], v2 offset:58368
    v_mfma_f32_16x16x32_bf16 v[20:23], v[60:63], v[164:167], v[20:23]
    ds_read_b128 v[204:207], v2 offset:59392
    v_mfma_f32_16x16x32_bf16 v[24:27], v[64:67], v[164:167], v[24:27]
    ds_read_b128 v[208:211], v2 offset:60416
    s_sub_u32 s41, s41, 1
    s_cmp_lg_u32 s41, 0
    s_cbranch_scc1 D_loop
    s_waitcnt vmcnt(4) lgkmcnt(5)
    s_barrier
    v_mfma_f32_16x16x32_bf16 v[8:11], v[68:71], v[168:171], v[8:11]
    ds_read_b128 v[28:31], v1 offset:0
    v_mfma_f32_16x16x32_bf16 v[12:15], v[72:75], v[168:171], v[12:15]
    ds_read_b128 v[32:35], v1 offset:1024
    v_mfma_f32_16x16x32_bf16 v[16:19], v[76:79], v[168:171], v[16:19]
    ds_read_b128 v[36:39], v1 offset:2048
    buffer_load_dwordx4 v[144:147], v2, s[16:19], s25 offen offset:0
    v_mfma_f32_16x16x32_bf16 v[20:23], v[80:83], v[168:171], v[20:23]
    ds_read_b128 v[40:43], v1 offset:3072
    buffer_load_dwordx4 v[148:151], v2, s[16:19], s25 offen offset:1024
    s_add_u32 s25, s25, 4096
    v_mfma_f32_16x16x32_bf16 v[24:27], v[84:87], v[168:171], v[24:27]
    ds_read_b128 v[44:47], v1 offset:4096
    s_waitcnt lgkmcnt(5)
    v_mfma_f32_16x16x32_bf16 v[8:11], v[192:195], v[172:175], v[8:11]
    ds_read_b128 v[48:51], v1 offset:5120
    v_mfma_f32_16x16x32_bf16 v[12:15], v[196:199], v[172:175], v[12:15]
    ds_read_b128 v[52:55], v1 offset:6144
    v_mfma_f32_16x16x32_bf16 v[16:19], v[200:203], v[172:175], v[16:19]
    ds_read_b128 v[56:59], v1 offset:7168
    v_mfma_f32_16x16x32_bf16 v[20:23], v[204:207], v[172:175], v[20:23]
    ds_read_b128 v[60:63], v1 offset:8192
    v_mfma_f32_16x16x32_bf16 v[24:27], v[208:211], v[172:175], v[24:27]
    ds_read_b128 v[64:67], v1 offset:9216
    s_waitcnt lgkmcnt(5)
    v_mfma_f32_16x16x32_bf16 v[8:11], v[28:31], v[176:179], v[8:11]
    ds_read_b128 v[68:71], v1 offset:10240
    v_mfma_f32_16x16x32_bf16 v[12:15], v[32:35], v[176:179], v[12:15]
    ds_read_b128 v[72:75], v1 offset:11264
    v_mfma_f32_16x16x32_bf16 v[16:19], v[36:39], v[176:179], v[16:19]
    ds_read_b128 v[76:79], v1 offset:12288
    v_mfma_f32_16x16x32_bf16 v[20:23], v[40:43], v[176:179], v[20:23]
    ds_read_b128 v[80:83], v1 offset:13312
    v_mfma_f32_16x16x32_bf16 v[24:27], v[44:47], v[176:179], v[24:27]
    ds_read_b128 v[84:87], v1 offset:14336
    s_waitcnt lgkmcnt(5)
    v_mfma_f32_16x16x32_bf16 v[8:11], v[48:51], v[180:183], v[8:11]
    ds_read_b128 v[192:195], v1 offset:15360
    v_mfma_f32_16x16x32_bf16 v[12:15], v[52:55], v[180:183], v[12:15]
    ds_read_b128 v[196:199], v1 offset:16384
    v_mfma_f32_16x16x32_bf16 v[16:19], v[56:59], v[180:183], v[16:19]
    ds_read_b128 v[200:203], v1 offset:17408
    v_mfma_f32_16x16x32_bf16 v[20:23], v[60:63], v[180:183], v[20:23]
    ds_read_b128 v[204:207], v1 offset:18432
    v_mfma_f32_16x16x32_bf16 v[24:27], v[64:67], v[180:183], v[24:27]
    ds_read_b128 v[208:211], v1 offset:19456
    s_waitcnt vmcnt(2) lgkmcnt(5)
    s_barrier
    v_mfma_f32_16x16x32_bf16 v[8:11], v[68:71], v[184:187], v[8:11]
    ds_read_b128 v[28:31], v2 offset:0
    v_mfma_f32_16x16x32_bf16 v[12:15], v[72:75], v[184:187], v[12:15]
    ds_read_b128 v[32:35], v2 offset:1024
    v_mfma_f32_16x16x32_bf16 v[16:19], v[76:79], v[184:187], v[16:19]
    ds_read_b128 v[36:39], v2 offset:2048
    v_mfma_f32_16x16x32_bf16 v[20:23], v[80:83], v[184:187], v[20:23]
    ds_read_b128 v[40:43], v2 offset:3072
    v_mfma_f32_16x16x32_bf16 v[24:27], v[84:87], v[184:187], v[24:27]
    ds_read_b128 v[44:47], v2 offset:4096
    s_waitcnt lgkmcnt(5)
    v_mfma_f32_16x16x32_bf16 v[8:11], v[192:195], v[188:191], v[8:11]
    ds_read_b128 v[48:51], v2 offset:5120
    v_mfma_f32_16x16x32_bf16 v[12:15], v[196:199], v[188:191], v[12:15]
    ds_read_b128 v[52:55], v2 offset:6144
    v_mfma_f32_16x16x32_bf16 v[16:19], v[200:203], v[188:191], v[16:19]
    ds_read_b128 v[56:59], v2 offset:7168
    v_mfma_f32_16x16x32_bf16 v[20:23], v[204:207], v[188:191], v[20:23]
    ds_read_b128 v[60:63], v2 offset:8192
    v_mfma_f32_16x16x32_bf16 v[24:27], v[208:211], v[188:191], v[24:27]
    ds_read_b128 v[64:67], v2 offset:9216
    s_waitcnt lgkmcnt(5)
    v_mfma_f32_16x16x32_bf16 v[8:11], v[28:31], v[128:131], v[8:11]
    ds_read_b128 v[68:71], v2 offset:10240
    v_mfma_f32_16x16x32_bf16 v[12:15], v[32:35], v[128:131], v[12:15]
    ds_read_b128 v[72:75], v2 offset:11264
    v_mfma_f32_16x16x32_bf16 v[16:19], v[36:39], v[128:131], v[16:19]
    ds_read_b128 v[76:79], v2 offset:12288
    v_mfma_f32_16x16x32_bf16 v[20:23], v[40:43], v[128:131], v[20:23]
    ds_read_b128 v[80:83], v2 offset:13312
    v_mfma_f32_16x16x32_bf16 v[24:27], v[44:47], v[128:131], v[24:27]
    ds_read_b128 v[84:87], v2 offset:14336
    s_waitcnt lgkmcnt(5)
    v_mfma_f32_16x16x32_bf16 v[8:11], v[48:51], v[132:135], v[8:11]
    ds_read_b128 v[192:195], v2 offset:15360
    v_mfma_f32_16x16x32_bf16 v[12:15], v[52:55], v[132:135], v[12:15]
    ds_read_b128 v[196:199], v2 offset:16384
    v_mfma_f32_16x16x32_bf16 v[16:19], v[56:59], v[132:135], v[16:19]
    ds_read_b128 v[200:203], v2 offset:17408
    v_mfma_f32_16x16x32_bf16 v[20:23], v[60:63], v[132:135], v[20:23]
    ds_read_b128 v[204:207], v2 offset:18432
    v_mfma_f32_16x16x32_bf16 v[24:27], v[64:67], v[132:135], v[24:27]
    ds_read_b128 v[208:211], v2 offset:19456
    s_waitcnt vmcnt(0) lgkmcnt(5)
    s_barrier
    v_mfma_f32_16x16x32_bf16 v[8:11], v[68:71], v[136:139], v[8:11]
    ds_read_b128 v[28:31], v2 offset:20480
    v_mfma_f32_16x16x32_bf16 v[12:15], v[72:75], v[136:139], v[12:15]
    ds_read_b128 v[32:35], v2 offset:21504
    v_mfma_f32_16x16x32_bf16 v[16:19], v[76:79], v[136:139], v[16:19]
    ds_read_b128 v[36:39], v2 offset:22528
    v_mfma_f32_16x16x32_bf16 v[20:23], v[80:83], v[136:139], v[20:23]
    ds_read_b128 v[40:43], v2 offset:23552
    v_mfma_f32_16x16x32_bf16 v[24:27], v[84:87], v[136:139], v[24:27]
    ds_read_b128 v[44:47], v2 offset:24576
    s_waitcnt lgkmcnt(5)
    v_mfma_f32_16x16x32_bf16 v[8:11], v[192:195], v[140:143], v[8:11]
    ds_read_b128 v[48:51], v2 offset:25600
    v_mfma_f32_16x16x32_bf16 v[12:15], v[196:199], v[140:143], v[12:15]
    ds_read_b128 v[52:55], v2 offset:26624
    v_mfma_f32_16x16x32_bf16 v[16:19], v[200:203], v[140:143], v[16:19]
    ds_read_b128 v[56:59], v2 offset:27648
    v_mfma_f32_16x16x32_bf16 v[20:23], v[204:207], v[140:143], v[20:23]
    ds_read_b128 v[60:63], v2 offset:28672
    v_mfma_f32_16x16x32_bf16 v[24:27], v[208:211], v[140:143], v[24:27]
    ds_read_b128 v[64:67], v2 offset:29696
    s_waitcnt lgkmcnt(5)
    v_mfma_f32_16x16x32_bf16 v[8:11], v[28:31], v[144:147], v[8:11]
    v_mfma_f32_16x16x32_bf16 v[12:15], v[32:35], v[144:147], v[12:15]
    v_mfma_f32_16x16x32_bf16 v[16:19], v[36:39], v[144:147], v[16:19]
    v_mfma_f32_16x16x32_bf16 v[20:23], v[40:43], v[144:147], v[20:23]
    v_mfma_f32_16x16x32_bf16 v[24:27], v[44:47], v[144:147], v[24:27]
    s_waitcnt lgkmcnt(0)
    v_mfma_f32_16x16x32_bf16 v[8:11], v[48:51], v[148:151], v[8:11]
    v_mfma_f32_16x16x32_bf16 v[12:15], v[52:55], v[148:151], v[12:15]
    v_mfma_f32_16x16x32_bf16 v[16:19], v[56:59], v[148:151], v[16:19]
    v_mfma_f32_16x16x32_bf16 v[20:23], v[60:63], v[148:151], v[20:23]
    v_mfma_f32_16x16x32_bf16 v[24:27], v[64:67], v[148:151], v[24:27]
    s_waitcnt vmcnt(0)
    v_lshlrev_b32 v88, 16, v88
    v_lshlrev_b32 v89, 16, v89
    v_lshlrev_b32 v90, 16, v90
    v_lshlrev_b32 v91, 16, v91
    v_lshlrev_b32 v92, 16, v92
    v_lshlrev_b32 v93, 16, v93
    v_lshlrev_b32 v94, 16, v94
    v_lshlrev_b32 v95, 16, v95
    v_lshlrev_b32 v96, 16, v96
    v_lshlrev_b32 v97, 16, v97
    v_lshlrev_b32 v98, 16, v98
    v_lshlrev_b32 v99, 16, v99
    v_lshlrev_b32 v100, 16, v100
    v_lshlrev_b32 v101, 16, v101
    v_lshlrev_b32 v102, 16, v102
    v_lshlrev_b32 v103, 16, v103
    v_lshlrev_b32 v104, 16, v104
    v_lshlrev_b32 v105, 16, v105
    v_lshlrev_b32 v106, 16, v106
    v_lshlrev_b32 v107, 16, v107
    v_add_f32 v88, v88, v8
    v_add_f32 v89, v89, v9
    v_add_f32 v90, v90, v10
    v_add_f32 v91, v91, v11
    v_add_f32 v92, v92, v12
    v_add_f32 v93, v93, v13
    v_add_f32 v94, v94, v14
    v_add_f32 v95, v95, v15
    v_add_f32 v96, v96, v16
    v_add_f32 v97, v97, v17
    v_add_f32 v98, v98, v18
    v_add_f32 v99, v99, v19
    v_add_f32 v100, v100, v20
    v_add_f32 v101, v101, v21
    v_add_f32 v102, v102, v22
    v_add_f32 v103, v103, v23
    v_add_f32 v104, v104, v24
    v_add_f32 v105, v105, v25
    v_add_f32 v106, v106, v26
    v_add_f32 v107, v107, v27
    v_cvt_pk_bf16_f32 v32, v88, v89
    v_cvt_pk_bf16_f32 v33, v90, v91
    v_cvt_pk_bf16_f32 v34, v92, v93
    v_cvt_pk_bf16_f32 v35, v94, v95
    v_cvt_pk_bf16_f32 v36, v96, v97
    v_cvt_pk_bf16_f32 v37, v98, v99
    v_cvt_pk_bf16_f32 v38, v100, v101
    v_cvt_pk_bf16_f32 v39, v102, v103
    v_cvt_pk_bf16_f32 v40, v104, v105
    v_cvt_pk_bf16_f32 v41, v106, v107
    ds_write_b64 v3, v[32:33] offset:0
    ds_write_b64 v3, v[34:35] offset:8
    ds_write_b64 v3, v[36:37] offset:16
    ds_write_b64 v3, v[38:39] offset:24
    ds_write_b64 v3, v[40:41] offset:32
    s_waitcnt lgkmcnt(0)
    ds_read_b128 v[44:47], v108
    ds_read_b128 v[48:51], v109
    ds_read_b128 v[52:55], v110
    s_waitcnt lgkmcnt(2)
    buffer_store_dwordx4 v[44:47], v111, s[36:39], s29 offen
    s_waitcnt lgkmcnt(1)
    buffer_store_dwordx4 v[48:51], v112, s[36:39], s29 offen
    s_waitcnt lgkmcnt(0)
    buffer_store_dwordx4 v[52:55], v113, s[36:39], s29 offen
D_end:
    s_endpgm
.section .rodata,"a"
.p2align 6
.amdhsa_kernel ka_kernel
  .amdhsa_next_free_vgpr 112
  .amdhsa_next_free_sgpr 96
  .amdhsa_accum_offset 112
  .amdhsa_group_segment_fixed_size 0
  .amdhsa_kernarg_size 128
  .amdhsa_user_sgpr_count 2
  .amdhsa_user_sgpr_kernarg_segment_ptr 1
  .amdhsa_system_sgpr_workgroup_id_x 1
.end_amdhsa_kernel
.p2align 6
.amdhsa_kernel kb_kernel
  .amdhsa_next_free_vgpr 240
  .amdhsa_next_free_sgpr 96
  .amdhsa_accum_offset 240
  .amdhsa_group_segment_fixed_size 0
  .amdhsa_kernarg_size 128
  .amdhsa_user_sgpr_count 2
  .amdhsa_user_sgpr_kernarg_segment_ptr 1
  .amdhsa_system_sgpr_workgroup_id_x 1
.end_amdhsa_kernel
.p2align 6
.amdhsa_kernel kc_kernel
  .amdhsa_next_free_vgpr 168
  .amdhsa_next_free_sgpr 96
  .amdhsa_accum_offset 168
  .amdhsa_group_segment_fixed_size 0
  .amdhsa_kernarg_size 128
  .amdhsa_user_sgpr_count 2
  .amdhsa_user_sgpr_kernarg_segment_ptr 1
  .amdhsa_system_sgpr_workgroup_id_x 1
.end_amdhsa_kernel
.p2align 6
.amdhsa_kernel kd_kernel
  .amdhsa_next_free_vgpr 224
  .amdhsa_next_free_sgpr 96
  .amdhsa_accum_offset 224
  .amdhsa_group_segment_fixed_size 0
  .amdhsa_kernarg_size 128
  .amdhsa_user_sgpr_count 2
  .amdhsa_user_sgpr_kernarg_segment_ptr 1
  .amdhsa_system_sgpr_workgroup_id_x 1
.end_amdhsa_kernel
```
